```python
import torch

def _softmax(x, axis=-1):
    return torch.softmax(x, dim=axis)
def _gelu(x):
    return torch.nn.functional.gelu(x, approximate="tanh")
def _silu(x):
    return torch.nn.functional.silu(x)
def _sigmoid(x):
    return torch.sigmoid(x)
def _layernorm(x, axis=-1, eps=1e-5):
    m = x.mean(dim=axis, keepdim=True)
    v = x.var(dim=axis, keepdim=True, unbiased=False)
    return (x - m) / torch.sqrt(v + eps)
def _scatter_add(tgt, idx, src, axis=0):
    return tgt.clone().index_add_(axis, idx, src)
def _segment_sum(src, seg, n):
    out = torch.zeros((n,) + src.shape[1:], dtype=src.dtype)
    return out.index_add_(0, seg, src)
def _pad(x, pw):
    flat = tuple(v for pair in reversed(pw) for v in pair)
    return torch.nn.functional.pad(x, flat)

kernel_name = 'concat_heads__sliding_block_cached__gqa_block_cached__decode'

def setup_inputs():

    _w = (lambda a: (lambda t: t.to(torch.bfloat16) if t.is_floating_point() else t)(torch.as_tensor(a)))
    def _A_setup():
        B, Sq, D = 4, 1, 1024
        Hq, Hkv, Sk, Dh = 32, 4, 8192, 128
        assert Hq % Hkv == 0, (Hq, Hkv)
        return {
            "x": _w((lambda *s: torch.randn(*s, dtype=torch.bfloat16) * 0.8)(B, Sq, D)),
            "k_cache": _w((lambda *s: torch.randn(*s, dtype=torch.bfloat16) * 1.6)(B, Hkv, Sk, Dh)),
            "v_cache": _w((lambda *s: torch.randn(*s, dtype=torch.bfloat16) * 0.2)(B, Hkv, Sk, Dh)),
            "wq": _w((lambda *s: torch.randn(*s, dtype=torch.bfloat16) * 1.6)(D, Hq * Dh) * (D ** -0.5)),
            "wo": _w((lambda *s: torch.randn(*s, dtype=torch.bfloat16) * 0.2)(Hq * Dh, D) * ((Hq * Dh) ** -0.5)),
        }
    _A_in = _A_setup()

    def _B_setup():
        B, Sq, D = 4, 1, 1024
        Hq, Hkv, Sk, Dh = 32, 4, 8192, 128
        assert Hq % Hkv == 0, (Hq, Hkv)
        return {
            "x": _w((lambda *s: torch.randn(*s, dtype=torch.bfloat16) * 0.8)(B, Sq, D)),
            "k_cache": _w((lambda *s: torch.randn(*s, dtype=torch.bfloat16) * 1.6)(B, Hkv, Sk, Dh)),
            "v_cache": _w((lambda *s: torch.randn(*s, dtype=torch.bfloat16) * 0.2)(B, Hkv, Sk, Dh)),
            "wq": _w((lambda *s: torch.randn(*s, dtype=torch.bfloat16) * 1.6)(D, Hq * Dh) * (D ** -0.5)),
            "wo": _w((lambda *s: torch.randn(*s, dtype=torch.bfloat16) * 0.2)(Hq * Dh, D) * ((Hq * Dh) ** -0.5)),
        }
    _B_in = _B_setup()

    return {
        "A_x": _A_in["x"],
        "A_k_cache": _A_in["k_cache"],
        "A_v_cache": _A_in["v_cache"],
        "A_wq": _A_in["wq"],
        "A_wo": _A_in["wo"],
        "B_x": _B_in["x"],
        "B_k_cache": _B_in["k_cache"],
        "B_v_cache": _B_in["v_cache"],
        "B_wq": _B_in["wq"],
        "B_wo": _B_in["wo"],
    }

def reference(A_x, A_k_cache, A_v_cache, A_wq, A_wo, B_x, B_k_cache, B_v_cache, B_wq, B_wo):
    def _A_ref(x, k_cache, v_cache, wq, wo):
        B, Sq, D = x.shape
        Hq, Dh = 32, 128
        Hkv, Sk = k_cache.shape[1], k_cache.shape[2]
        W = min(4096, max(256, Sk // 4))
        rep = Hq // Hkv
        q = (lambda x, *d: x.permute(*d))((x @ wq).reshape(B, Sq, Hq, Dh), 0, 2, 1, 3)
        k = (lambda x, n, axis: torch.repeat_interleave(x, n, dim=axis))(k_cache[:, :, Sk - W:, :], rep, axis=1)
        v = (lambda x, n, axis: torch.repeat_interleave(x, n, dim=axis))(v_cache[:, :, Sk - W:, :], rep, axis=1)
        scores = torch.einsum("bhqd,bhkd->bhqk", q, k) * (Dh ** -0.5)
        p = _softmax(scores, axis=-1)
        o = torch.einsum("bhqk,bhkd->bhqd", p, v)
        return (lambda x, *d: x.permute(*d))(o, 0, 2, 1, 3).reshape(B, Sq, Hq * Dh) @ wo

    def _B_ref(x, k_cache, v_cache, wq, wo):
        B, Sq, D = x.shape
        Hq, Dh = 32, 128
        Hkv = k_cache.shape[1]
        rep = Hq // Hkv
        q = (lambda x, *d: x.permute(*d))((x @ wq).reshape(B, Sq, Hq, Dh), 0, 2, 1, 3)
        k = (lambda x, n, axis: torch.repeat_interleave(x, n, dim=axis))(k_cache, rep, axis=1)
        v = (lambda x, n, axis: torch.repeat_interleave(x, n, dim=axis))(v_cache, rep, axis=1)
        scores = torch.einsum("bhqd,bhkd->bhqk", q, k) * (Dh ** -0.5)
        p = _softmax(scores, axis=-1)
        o = torch.einsum("bhqk,bhkd->bhqd", p, v)
        return (lambda x, *d: x.permute(*d))(o, 0, 2, 1, 3).reshape(B, Sq, Hq * Dh) @ wo

    a = _A_ref(A_x, A_k_cache, A_v_cache, A_wq, A_wo)
    b = _B_ref(B_x, B_k_cache, B_v_cache, B_wq, B_wo)
    return torch.concatenate([a, b], axis=-1)
```

```asm
; @launch grid=(256,1,1) block=(512,1,1) lds=149888
.amdgcn_target "amdgcn-amd-amdhsa--gfx950"
.text
.globl concat_heads__sliding_block_cached__gqa_block_cached__decode_kernel
.p2align 8
.type concat_heads__sliding_block_cached__gqa_block_cached__decode_kernel,@function
concat_heads__sliding_block_cached__gqa_block_cached__decode_kernel:
s_load_dwordx16 s[4:19], s[0:1], 0
s_load_dwordx8 s[20:27], s[0:1], 64
s_load_dwordx2 s[28:29], s[0:1], 96
v_readfirstlane_b32 s31, v0
s_cmp_ge_u32 s2, 256
s_cbranch_scc1 L_end
v_and_b32 v0, 63, v0
s_bfe_u32 s78, s2, 0x60001
s_xor_b32 s78, s78, 3
s_lshr_b32 s79, s2, 7
s_bfe_u32 s3, s31, 0x20006
s_mul_i32 s77, s3, 28672
s_and_b32 s30, s2, 1
s_bitcmp1_b32 s31, 8
s_cbranch_scc1 L_cons
v_lshrrev_b32 v1, 3, v0
v_and_b32 v2, 7, v0
v_and_b32 v3, 2, v1
v_xor_b32 v2, v2, v3
v_lshlrev_b32 v2, 4, v2
v_lshl_add_u32 v9, v1, 13, v2
v_xor_b32 v10, 64, v9
s_lshl2_add_u32 s31, s79, s3
s_lshl_b32 s31, s31, 20
s_lshl_b32 s72, s78, 7
s_add_u32 s72, s72, s31
s_mov_b32 s34, 8388608
s_mov_b32 s35, 0x20000
s_cmp_eq_u32 s30, 0
s_waitcnt lgkmcnt(0)
s_cselect_b32 s32, s10, s20
s_cselect_b32 s33, s11, s21
s_add_u32 m0, s77, 0
s_add_u32 s98, s72, 0
buffer_load_dwordx4 v9, s[32:35], s98 offen offset:0 nt lds
s_add_u32 s98, s72, 64512
buffer_load_dwordx4 v10, s[32:35], s98 offen offset:1024 nt lds
s_add_u32 s98, s72, 129024
buffer_load_dwordx4 v9, s[32:35], s98 offen offset:2048 nt lds
s_add_u32 s98, s72, 193536
buffer_load_dwordx4 v10, s[32:35], s98 offen offset:3072 nt lds
s_add_u32 m0, s77, 4096
s_add_u32 s98, s72, 262144
buffer_load_dwordx4 v9, s[32:35], s98 offen offset:0 nt lds
s_add_u32 s98, s72, 326656
buffer_load_dwordx4 v10, s[32:35], s98 offen offset:1024 nt lds
s_add_u32 s98, s72, 391168
buffer_load_dwordx4 v9, s[32:35], s98 offen offset:2048 nt lds
s_add_u32 s98, s72, 455680
buffer_load_dwordx4 v10, s[32:35], s98 offen offset:3072 nt lds
s_setprio 3
v_lshlrev_b32 v4, 4, v0
v_and_b32 v3, 3, v1
v_lshl_add_u32 v2, v3, 18, v2
v_lshrrev_b32 v3, 2, v1
v_lshl_add_u32 v11, v3, 11, v2
v_xor_b32 v12, 64, v11
s_mov_b32 s101, s30
s_mov_b32 s54, 8388608
s_mov_b32 s55, 0x20000
s_cmp_eq_u32 s101, 0
s_cselect_b32 s52, s12, s22
s_cselect_b32 s53, s13, s23
s_mov_b32 s36, s6
s_mov_b32 s37, s7
s_mov_b32 s38, 33554432
s_mov_b32 s39, 0x20000
s_mov_b32 s40, s8
s_mov_b32 s41, s9
s_mov_b32 s42, 33554432
s_mov_b32 s43, 0x20000
s_mov_b32 s44, s16
s_mov_b32 s45, s17
s_mov_b32 s46, 33554432
s_mov_b32 s47, 0x20000
s_mov_b32 s48, s18
s_mov_b32 s49, s19
s_mov_b32 s50, 33554432
s_mov_b32 s51, 0x20000
s_mov_b32 s56, s28
s_mov_b32 s57, s29
s_mov_b32 s58, 2621440
s_mov_b32 s59, 0x20000
s_and_b32 s4, s2, 15
s_lshr_b32 s5, s2, 4
s_bfe_u32 s6, s2, 0x20001
s_lshr_b32 s7, s2, 5
s_lshl_b32 s7, s7, 2
s_or_b32 s6, s6, s7
s_bfe_u32 s7, s2, 0x20003
s_lshr_b32 s13, s2, 3
s_add_u32 s13, s13, s3
s_and_b32 s13, s13, 3
s_lshl_b32 s13, s13, 12
s_lshl_b32 s14, s4, 21
s_add_u32 s13, s13, s14
s_lshl_b32 s74, s5, 15
s_add_u32 s74, s74, s13
s_add_u32 s74, s74, 1572864
s_lshl_b32 s75, s5, 17
s_add_u32 s75, s75, s13
s_lshr_b32 s76, s2, 5
s_lshl1_add_u32 s76, s3, s76
s_add_u32 s76, s76, s2
s_lshl_b32 s76, s76, 14
v_lshrrev_b32 v1, 4, v0
v_and_b32 v2, 15, v0
v_lshlrev_b32 v3, 1, v1
v_xor_b32 v2, v2, v3
v_lshlrev_b32 v2, 4, v2
v_lshl_add_u32 v5, v1, 8, v2
v_xor_b32 v6, 128, v5
v_xor_b32 v7, 16, v5
v_xor_b32 v8, 144, v5
v_add_u32 v26, 146816, v4
s_lshl_b32 s13, s3, 2
v_add_u32 v25, s13, v26
s_lshr_b32 s13, s32, 7
s_add_u32 s13, s13, s78
s_and_b32 s13, s13, 7
s_cmp_eq_u32 s13, 3
s_cbranch_scc1 L_deep
s_waitcnt vmcnt(7)
s_waitcnt vmcnt(6)
s_waitcnt vmcnt(5)
s_add_u32 m0, s77, 8192
s_add_u32 s98, s76, 0
s_and_b32 s98, s98, 32767
s_add_u32 s98, s98, s74
buffer_load_dwordx4 v5, s[36:39], s98 offen offset:0 nt lds
s_waitcnt vmcnt(5)
s_barrier
v_mov_b32 v1, 1
ds_max_u32 v25, v1
buffer_load_dwordx4 v6, s[36:39], s98 offen offset:1024 nt lds
s_waitcnt vmcnt(5)
buffer_load_dwordx4 v7, s[36:39], s98 offen offset:2048 nt lds
s_waitcnt vmcnt(5)
buffer_load_dwordx4 v8, s[36:39], s98 offen offset:3072 nt lds
s_waitcnt vmcnt(5)
s_add_u32 m0, s77, 12288
s_add_u32 s98, s72, 524288
buffer_load_dwordx4 v9, s[32:35], s98 offen offset:0 nt lds
s_waitcnt vmcnt(5)
v_mov_b32 v1, 2
ds_max_u32 v25, v1
s_add_u32 s98, s72, 588800
buffer_load_dwordx4 v10, s[32:35], s98 offen offset:1024 nt lds
s_waitcnt vmcnt(5)
s_add_u32 s98, s72, 653312
buffer_load_dwordx4 v9, s[32:35], s98 offen offset:2048 nt lds
s_waitcnt vmcnt(5)
s_add_u32 s98, s72, 717824
buffer_load_dwordx4 v10, s[32:35], s98 offen offset:3072 nt lds
s_waitcnt vmcnt(5)
s_add_u32 m0, s77, 16384
s_add_u32 s98, s76, 16384
s_and_b32 s98, s98, 32767
s_add_u32 s98, s98, s74
buffer_load_dwordx4 v5, s[36:39], s98 offen offset:0 nt lds
s_waitcnt vmcnt(5)
v_mov_b32 v1, 3
ds_max_u32 v25, v1
buffer_load_dwordx4 v6, s[36:39], s98 offen offset:1024 nt lds
s_waitcnt vmcnt(5)
buffer_load_dwordx4 v7, s[36:39], s98 offen offset:2048 nt lds
s_waitcnt vmcnt(5)
buffer_load_dwordx4 v8, s[36:39], s98 offen offset:3072 nt lds
s_waitcnt vmcnt(5)
s_add_u32 m0, s77, 20480
s_add_u32 s98, s72, 786432
buffer_load_dwordx4 v9, s[32:35], s98 offen offset:0 nt lds
s_waitcnt vmcnt(5)
v_mov_b32 v1, 4
ds_max_u32 v25, v1
s_add_u32 s98, s72, 850944
buffer_load_dwordx4 v10, s[32:35], s98 offen offset:1024 nt lds
s_waitcnt vmcnt(5)
s_add_u32 s98, s72, 915456
buffer_load_dwordx4 v9, s[32:35], s98 offen offset:2048 nt lds
s_waitcnt vmcnt(5)
s_add_u32 s98, s72, 979968
buffer_load_dwordx4 v10, s[32:35], s98 offen offset:3072 nt lds
s_waitcnt vmcnt(5)
s_add_u32 m0, s77, 24576
s_add_u32 s98, s76, 0
s_and_b32 s98, s98, 131071
s_add_u32 s98, s98, s75
buffer_load_dwordx4 v5, s[44:47], s98 offen offset:0 nt lds
s_waitcnt vmcnt(5)
v_mov_b32 v1, 5
ds_max_u32 v25, v1
buffer_load_dwordx4 v6, s[44:47], s98 offen offset:1024 nt lds
s_waitcnt vmcnt(5)
buffer_load_dwordx4 v7, s[44:47], s98 offen offset:2048 nt lds
s_waitcnt vmcnt(5)
buffer_load_dwordx4 v8, s[44:47], s98 offen offset:3072 nt lds
ds_read_b32 v29, v25 offset:1024
s_waitcnt vmcnt(5)
s_waitcnt lgkmcnt(0)
v_cmp_gt_u32 vcc, 1, v29
s_cbranch_vccnz L_slow22
L_back22:
s_add_u32 m0, s77, 0
s_add_u32 s98, s76, 16384
s_and_b32 s98, s98, 131071
s_add_u32 s98, s98, s75
buffer_load_dwordx4 v5, s[44:47], s98 offen offset:0 nt lds
s_waitcnt vmcnt(5)
v_mov_b32 v1, 6
ds_max_u32 v25, v1
buffer_load_dwordx4 v6, s[44:47], s98 offen offset:1024 nt lds
s_lshr_b32 s73, s6, 2
s_lshl_b32 s73, s73, 20
s_and_b32 s13, s6, 3
s_lshl_b32 s13, s13, 16
s_add_u32 s73, s73, s13
s_lshl_b32 s13, s7, 9
s_add_u32 s73, s73, s13
s_lshl_b32 s13, s3, 7
s_add_u32 s73, s73, s13
v_lshrrev_b32 v1, 3, v0
v_lshlrev_b32 v1, 12, v1
v_and_b32 v2, 7, v0
v_lshl_add_u32 v22, v2, 4, v1
s_lshl_b32 s10, s101, 18
s_lshl_b32 s11, s7, 16
s_add_u32 s10, s10, s11
s_lshl_b32 s11, s3, 14
s_add_u32 s10, s10, s11
s_lshl_b32 s11, s6, 7
s_add_u32 s10, s10, s11
s_add_u32 s10, s10, 1572864
v_bfe_u32 v1, v0, 3, 2
v_lshlrev_b32 v1, 5, v1
v_and_b32 v2, 3, v0
v_lshl_add_u32 v1, v2, 3, v1
v_bfe_u32 v2, v0, 2, 2
v_lshl_add_u32 v1, v2, 7, v1
v_lshrrev_b32 v2, 4, v0
v_lshl_add_u32 v1, v2, 10, v1
v_add_u32 v17, s77, v1
v_xor_b32 v18, 32, v17
v_xor_b32 v19, 64, v17
v_xor_b32 v20, 96, v17
s_mov_b32 s14, 0xf0f0f0f0
s_mov_b32 s15, s14
s_mov_b32 s16, 0xff00ff00
s_mov_b32 s17, s16
v_and_b32 v1, 3, v0
v_mul_u32_u24 v1, 272, v1
v_lshrrev_b32 v2, 4, v0
v_lshl_add_u32 v1, v2, 4, v1
v_add_u32 v23, 144640, v1
v_mov_b32 v24, 145728
s_mov_b32 s18, 0xffffff00
s_mov_b32 s14, 0xffff0000
s_mov_b32 s15, s14
s_mov_b32 s16, 0
s_mov_b32 s17, -1
s_waitcnt vmcnt(5)
buffer_load_dwordx4 v7, s[44:47], s98 offen offset:2048 nt lds
s_waitcnt vmcnt(5)
buffer_load_dwordx4 v8, s[44:47], s98 offen offset:3072 nt lds
ds_read_b32 v29, v25 offset:1024
s_waitcnt vmcnt(5)
s_waitcnt lgkmcnt(0)
v_cmp_gt_u32 vcc, 2, v29
s_cbranch_vccnz L_slow23
L_back23:
s_add_u32 m0, s77, 4096
s_add_u32 s98, s76, 32768
s_and_b32 s98, s98, 131071
s_add_u32 s98, s98, s75
buffer_load_dwordx4 v5, s[44:47], s98 offen offset:0 nt lds
s_waitcnt vmcnt(5)
v_mov_b32 v1, 7
ds_max_u32 v25, v1
buffer_load_dwordx4 v6, s[44:47], s98 offen offset:1024 nt lds
s_waitcnt vmcnt(5)
buffer_load_dwordx4 v7, s[44:47], s98 offen offset:2048 nt lds
s_waitcnt vmcnt(5)
buffer_load_dwordx4 v8, s[44:47], s98 offen offset:3072 nt lds
ds_read_b32 v29, v25 offset:1024
s_waitcnt vmcnt(5)
s_waitcnt lgkmcnt(0)
v_cmp_gt_u32 vcc, 3, v29
s_cbranch_vccnz L_slow24
L_back24:
s_add_u32 m0, s77, 8192
s_add_u32 s98, s76, 49152
s_and_b32 s98, s98, 131071
s_add_u32 s98, s98, s75
buffer_load_dwordx4 v5, s[44:47], s98 offen offset:0 nt lds
s_waitcnt vmcnt(5)
v_mov_b32 v1, 8
ds_max_u32 v25, v1
buffer_load_dwordx4 v6, s[44:47], s98 offen offset:1024 nt lds
s_waitcnt vmcnt(5)
buffer_load_dwordx4 v7, s[44:47], s98 offen offset:2048 nt lds
s_waitcnt vmcnt(5)
buffer_load_dwordx4 v8, s[44:47], s98 offen offset:3072 nt lds
ds_read_b32 v29, v25 offset:1024
s_waitcnt vmcnt(5)
s_waitcnt lgkmcnt(0)
v_cmp_gt_u32 vcc, 4, v29
s_cbranch_vccnz L_slow25
L_back25:
s_add_u32 m0, s77, 12288
s_add_u32 s98, s76, 65536
s_and_b32 s98, s98, 131071
s_add_u32 s98, s98, s75
buffer_load_dwordx4 v5, s[44:47], s98 offen offset:0 nt lds
s_waitcnt vmcnt(5)
v_mov_b32 v1, 9
ds_max_u32 v25, v1
buffer_load_dwordx4 v6, s[44:47], s98 offen offset:1024 nt lds
s_waitcnt vmcnt(5)
buffer_load_dwordx4 v7, s[44:47], s98 offen offset:2048 nt lds
s_waitcnt vmcnt(5)
buffer_load_dwordx4 v8, s[44:47], s98 offen offset:3072 nt lds
ds_read_b32 v29, v25 offset:1024
s_waitcnt vmcnt(5)
s_waitcnt lgkmcnt(0)
v_cmp_gt_u32 vcc, 5, v29
s_cbranch_vccnz L_slow26
L_back26:
s_add_u32 m0, s77, 16384
s_add_u32 s98, s76, 81920
s_and_b32 s98, s98, 131071
s_add_u32 s98, s98, s75
buffer_load_dwordx4 v5, s[44:47], s98 offen offset:0 nt lds
s_waitcnt vmcnt(5)
v_mov_b32 v1, 10
ds_max_u32 v25, v1
buffer_load_dwordx4 v6, s[44:47], s98 offen offset:1024 nt lds
s_waitcnt vmcnt(5)
buffer_load_dwordx4 v7, s[44:47], s98 offen offset:2048 nt lds
s_waitcnt vmcnt(5)
buffer_load_dwordx4 v8, s[44:47], s98 offen offset:3072 nt lds
ds_read_b32 v29, v25 offset:1024
s_waitcnt vmcnt(5)
s_waitcnt lgkmcnt(0)
v_cmp_gt_u32 vcc, 6, v29
s_cbranch_vccnz L_slow27
L_back27:
s_add_u32 m0, s77, 20480
s_add_u32 s98, s76, 98304
s_and_b32 s98, s98, 131071
s_add_u32 s98, s98, s75
buffer_load_dwordx4 v5, s[44:47], s98 offen offset:0 nt lds
s_waitcnt vmcnt(5)
v_mov_b32 v1, 11
ds_max_u32 v25, v1
buffer_load_dwordx4 v6, s[44:47], s98 offen offset:1024 nt lds
s_waitcnt vmcnt(5)
buffer_load_dwordx4 v7, s[44:47], s98 offen offset:2048 nt lds
s_waitcnt vmcnt(5)
buffer_load_dwordx4 v8, s[44:47], s98 offen offset:3072 nt lds
ds_read_b32 v29, v25 offset:1024
s_waitcnt vmcnt(5)
s_waitcnt lgkmcnt(0)
v_cmp_gt_u32 vcc, 7, v29
s_cbranch_vccnz L_slow28
L_back28:
s_add_u32 m0, s77, 24576
s_add_u32 s98, s76, 114688
s_and_b32 s98, s98, 131071
s_add_u32 s98, s98, s75
buffer_load_dwordx4 v5, s[44:47], s98 offen offset:0 nt lds
s_waitcnt vmcnt(5)
v_mov_b32 v1, 12
ds_max_u32 v25, v1
buffer_load_dwordx4 v6, s[44:47], s98 offen offset:1024 nt lds
s_waitcnt vmcnt(5)
buffer_load_dwordx4 v7, s[44:47], s98 offen offset:2048 nt lds
s_waitcnt vmcnt(5)
buffer_load_dwordx4 v8, s[44:47], s98 offen offset:3072 nt lds
ds_read_b32 v29, v25 offset:1024
s_waitcnt vmcnt(5)
s_waitcnt lgkmcnt(0)
v_cmp_gt_u32 vcc, 8, v29
s_cbranch_vccnz L_slow29
L_back29:
s_add_u32 m0, s77, 0
s_add_u32 s98, s76, 0
s_and_b32 s98, s98, 32767
s_add_u32 s98, s98, s74
buffer_load_dwordx4 v5, s[40:43], s98 offen offset:0 nt lds
s_waitcnt vmcnt(5)
v_mov_b32 v1, 13
ds_max_u32 v25, v1
buffer_load_dwordx4 v6, s[40:43], s98 offen offset:1024 nt lds
s_waitcnt vmcnt(5)
buffer_load_dwordx4 v7, s[40:43], s98 offen offset:2048 nt lds
s_waitcnt vmcnt(5)
buffer_load_dwordx4 v8, s[40:43], s98 offen offset:3072 nt lds
ds_read_b32 v29, v25 offset:1024
s_waitcnt vmcnt(5)
s_waitcnt lgkmcnt(0)
v_cmp_gt_u32 vcc, 9, v29
s_cbranch_vccnz L_slow30
L_back30:
s_add_u32 m0, s77, 4096
s_add_u32 s98, s76, 16384
s_and_b32 s98, s98, 32767
s_add_u32 s98, s98, s74
buffer_load_dwordx4 v5, s[40:43], s98 offen offset:0 nt lds
s_waitcnt vmcnt(5)
v_mov_b32 v1, 14
ds_max_u32 v25, v1
buffer_load_dwordx4 v6, s[40:43], s98 offen offset:1024 nt lds
s_waitcnt vmcnt(5)
buffer_load_dwordx4 v7, s[40:43], s98 offen offset:2048 nt lds
s_waitcnt vmcnt(5)
buffer_load_dwordx4 v8, s[40:43], s98 offen offset:3072 nt lds
ds_read_b32 v29, v25 offset:1024
s_waitcnt vmcnt(5)
s_waitcnt lgkmcnt(0)
v_cmp_gt_u32 vcc, 10, v29
s_cbranch_vccnz L_slow31
L_back31:
s_add_u32 m0, s77, 8192
s_add_u32 s98, s76, 0
s_and_b32 s98, s98, 131071
s_add_u32 s98, s98, s75
buffer_load_dwordx4 v5, s[48:51], s98 offen offset:0 nt lds
s_waitcnt vmcnt(5)
v_mov_b32 v1, 15
ds_max_u32 v25, v1
buffer_load_dwordx4 v6, s[48:51], s98 offen offset:1024 nt lds
s_waitcnt vmcnt(5)
buffer_load_dwordx4 v7, s[48:51], s98 offen offset:2048 nt lds
s_waitcnt vmcnt(5)
buffer_load_dwordx4 v8, s[48:51], s98 offen offset:3072 nt lds
ds_read_b32 v29, v25 offset:1024
s_waitcnt vmcnt(5)
s_waitcnt lgkmcnt(0)
v_cmp_gt_u32 vcc, 11, v29
s_cbranch_vccnz L_slow32
L_back32:
s_add_u32 m0, s77, 12288
s_add_u32 s98, s76, 16384
s_and_b32 s98, s98, 131071
s_add_u32 s98, s98, s75
buffer_load_dwordx4 v5, s[48:51], s98 offen offset:0 nt lds
s_waitcnt vmcnt(5)
v_mov_b32 v1, 16
ds_max_u32 v25, v1
buffer_load_dwordx4 v6, s[48:51], s98 offen offset:1024 nt lds
s_waitcnt vmcnt(5)
buffer_load_dwordx4 v7, s[48:51], s98 offen offset:2048 nt lds
s_waitcnt vmcnt(5)
buffer_load_dwordx4 v8, s[48:51], s98 offen offset:3072 nt lds
ds_read_b32 v29, v25 offset:1024
s_waitcnt vmcnt(5)
s_waitcnt lgkmcnt(0)
v_cmp_gt_u32 vcc, 12, v29
s_cbranch_vccnz L_slow33
L_back33:
s_add_u32 m0, s77, 16384
s_add_u32 s98, s76, 32768
s_and_b32 s98, s98, 131071
s_add_u32 s98, s98, s75
buffer_load_dwordx4 v5, s[48:51], s98 offen offset:0 nt lds
s_waitcnt vmcnt(5)
v_mov_b32 v1, 17
ds_max_u32 v25, v1
buffer_load_dwordx4 v6, s[48:51], s98 offen offset:1024 nt lds
s_waitcnt vmcnt(5)
buffer_load_dwordx4 v7, s[48:51], s98 offen offset:2048 nt lds
s_waitcnt vmcnt(5)
buffer_load_dwordx4 v8, s[48:51], s98 offen offset:3072 nt lds
ds_read_b32 v29, v25 offset:1024
s_waitcnt vmcnt(5)
s_waitcnt lgkmcnt(0)
v_cmp_gt_u32 vcc, 13, v29
s_cbranch_vccnz L_slow34
L_back34:
s_add_u32 m0, s77, 20480
s_add_u32 s98, s76, 49152
s_and_b32 s98, s98, 131071
s_add_u32 s98, s98, s75
buffer_load_dwordx4 v5, s[48:51], s98 offen offset:0 nt lds
s_waitcnt vmcnt(5)
v_mov_b32 v1, 18
ds_max_u32 v25, v1
buffer_load_dwordx4 v6, s[48:51], s98 offen offset:1024 nt lds
s_waitcnt vmcnt(5)
buffer_load_dwordx4 v7, s[48:51], s98 offen offset:2048 nt lds
s_waitcnt vmcnt(5)
buffer_load_dwordx4 v8, s[48:51], s98 offen offset:3072 nt lds
ds_read_b32 v29, v25 offset:1024
s_waitcnt vmcnt(5)
s_waitcnt lgkmcnt(0)
v_cmp_gt_u32 vcc, 14, v29
s_cbranch_vccnz L_slow35
L_back35:
s_add_u32 m0, s77, 24576
s_add_u32 s98, s76, 65536
s_and_b32 s98, s98, 131071
s_add_u32 s98, s98, s75
buffer_load_dwordx4 v5, s[48:51], s98 offen offset:0 nt lds
s_waitcnt vmcnt(5)
v_mov_b32 v1, 19
ds_max_u32 v25, v1
buffer_load_dwordx4 v6, s[48:51], s98 offen offset:1024 nt lds
s_waitcnt vmcnt(5)
buffer_load_dwordx4 v7, s[48:51], s98 offen offset:2048 nt lds
s_waitcnt vmcnt(5)
buffer_load_dwordx4 v8, s[48:51], s98 offen offset:3072 nt lds
ds_read_b128 v[136:139], v26 offset:1024
s_waitcnt vmcnt(5)
s_waitcnt lgkmcnt(0)
v_min_u32 v29, v136, v137
v_min3_u32 v29, v138, v139, v29
v_cmp_gt_u32 vcc, 15, v29
s_cbranch_vccnz L_slow36
L_back36:
s_add_u32 m0, s77, 0
s_add_u32 s98, s76, 81920
s_and_b32 s98, s98, 131071
s_add_u32 s98, s98, s75
buffer_load_dwordx4 v5, s[48:51], s98 offen offset:0 nt lds
s_waitcnt vmcnt(5)
v_mov_b32 v1, 20
ds_max_u32 v25, v1
buffer_load_dwordx4 v6, s[48:51], s98 offen offset:1024 nt lds
s_waitcnt vmcnt(5)
buffer_load_dwordx4 v7, s[48:51], s98 offen offset:2048 nt lds
s_waitcnt vmcnt(5)
buffer_load_dwordx4 v8, s[48:51], s98 offen offset:3072 nt lds
ds_read_b128 v[136:139], v26 offset:1024
s_waitcnt vmcnt(5)
s_waitcnt lgkmcnt(0)
v_min_u32 v29, v136, v137
v_min3_u32 v29, v138, v139, v29
v_cmp_gt_u32 vcc, 16, v29
s_cbranch_vccnz L_slow37
L_back37:
s_add_u32 m0, s77, 4096
s_add_u32 s98, s76, 98304
s_and_b32 s98, s98, 131071
s_add_u32 s98, s98, s75
buffer_load_dwordx4 v5, s[48:51], s98 offen offset:0 nt lds
s_waitcnt vmcnt(5)
v_mov_b32 v1, 21
ds_max_u32 v25, v1
buffer_load_dwordx4 v6, s[48:51], s98 offen offset:1024 nt lds
ds_read_b32 v144, v24
s_waitcnt vmcnt(5)
buffer_load_dwordx4 v7, s[48:51], s98 offen offset:2048 nt lds
s_waitcnt vmcnt(5)
buffer_load_dwordx4 v8, s[48:51], s98 offen offset:3072 nt lds
ds_read_b128 v[136:139], v26 offset:1024
s_waitcnt vmcnt(5)
s_waitcnt lgkmcnt(0)
v_min_u32 v29, v136, v137
v_min3_u32 v29, v138, v139, v29
v_cmp_gt_u32 vcc, 17, v29
s_cbranch_vccnz L_slow38
L_back38:
s_add_u32 m0, s77, 8192
s_add_u32 s98, s76, 114688
s_and_b32 s98, s98, 131071
s_add_u32 s98, s98, s75
buffer_load_dwordx4 v5, s[48:51], s98 offen offset:0 nt lds
s_waitcnt vmcnt(5)
v_mov_b32 v1, 22
ds_max_u32 v25, v1
buffer_load_dwordx4 v6, s[48:51], s98 offen offset:1024 nt lds
s_waitcnt vmcnt(5)
buffer_load_dwordx4 v7, s[48:51], s98 offen offset:2048 nt lds
s_waitcnt vmcnt(5)
buffer_load_dwordx4 v8, s[48:51], s98 offen offset:3072 nt lds
ds_read_b128 v[136:139], v26 offset:1024
s_waitcnt vmcnt(5)
s_waitcnt lgkmcnt(0)
v_min_u32 v29, v136, v137
v_min3_u32 v29, v138, v139, v29
v_cmp_gt_u32 vcc, 18, v29
s_cbranch_vccnz L_slow39
L_back39:
s_add_u32 m0, s77, 12288
s_add_u32 s98, s73, 0
buffer_load_dwordx4 v11, s[52:55], s98 offen offset:0 nt lds
s_waitcnt vmcnt(5)
v_mov_b32 v1, 23
ds_max_u32 v25, v1
s_add_u32 s98, s73, 3072
buffer_load_dwordx4 v12, s[52:55], s98 offen offset:1024 nt lds
s_waitcnt lgkmcnt(0)
v_and_b32 v2, 7, v0
v_lshlrev_b32 v2, 2, v2
v_lshrrev_b32 v2, v2, v144
v_bfe_u32 v140, v2, 0, 1
v_bfe_u32 v141, v2, 1, 1
v_bfe_u32 v142, v2, 2, 1
v_bfe_u32 v143, v2, 3, 1
s_waitcnt vmcnt(5)
s_add_u32 s98, s73, 6144
buffer_load_dwordx4 v11, s[52:55], s98 offen offset:2048 nt lds
s_waitcnt vmcnt(5)
s_add_u32 s98, s73, 9216
buffer_load_dwordx4 v12, s[52:55], s98 offen offset:3072 nt lds
ds_read_b128 v[136:139], v26 offset:1024
s_waitcnt vmcnt(5)
s_waitcnt lgkmcnt(0)
v_min_u32 v29, v136, v137
v_min3_u32 v29, v138, v139, v29
v_cmp_gt_u32 vcc, 19, v29
s_cbranch_vccnz L_slow40
L_back40:
s_add_u32 m0, s77, 16384
s_add_u32 s98, s73, 16384
buffer_load_dwordx4 v11, s[52:55], s98 offen offset:0 nt lds
s_waitcnt vmcnt(5)
v_mov_b32 v1, 24
ds_max_u32 v25, v1
s_add_u32 s98, s73, 19456
buffer_load_dwordx4 v12, s[52:55], s98 offen offset:1024 nt lds
s_waitcnt vmcnt(5)
s_add_u32 s98, s73, 22528
buffer_load_dwordx4 v11, s[52:55], s98 offen offset:2048 nt lds
s_waitcnt vmcnt(5)
s_add_u32 s98, s73, 25600
buffer_load_dwordx4 v12, s[52:55], s98 offen offset:3072 nt lds
ds_read_b128 v[136:139], v26 offset:1024
s_waitcnt vmcnt(5)
s_waitcnt lgkmcnt(0)
v_min_u32 v29, v136, v137
v_min3_u32 v29, v138, v139, v29
v_cmp_gt_u32 vcc, 20, v29
s_cbranch_vccnz L_slow41
L_back41:
s_add_u32 m0, s77, 20480
s_add_u32 s98, s73, 32768
buffer_load_dwordx4 v11, s[52:55], s98 offen offset:0 nt lds
s_waitcnt vmcnt(5)
s_add_u32 s98, s73, 35840
buffer_load_dwordx4 v12, s[52:55], s98 offen offset:1024 nt lds
ds_read_b64_tr_b16 v[64:65], v17 offset:12288
ds_read_b64_tr_b16 v[66:67], v17 offset:12800
ds_read_b64_tr_b16 v[68:69], v18 offset:12288
ds_read_b64_tr_b16 v[70:71], v18 offset:12800
ds_read_b64_tr_b16 v[72:73], v19 offset:12288
ds_read_b64_tr_b16 v[74:75], v19 offset:12800
ds_read_b64_tr_b16 v[76:77], v20 offset:12288
ds_read_b64_tr_b16 v[78:79], v20 offset:12800
s_waitcnt vmcnt(5)
s_add_u32 s98, s73, 38912
buffer_load_dwordx4 v11, s[52:55], s98 offen offset:2048 nt lds
s_waitcnt vmcnt(5)
s_add_u32 s98, s73, 41984
buffer_load_dwordx4 v12, s[52:55], s98 offen offset:3072 nt lds
ds_read_b128 v[136:139], v26 offset:1024
s_waitcnt vmcnt(5)
s_waitcnt lgkmcnt(0)
v_min_u32 v29, v136, v137
v_min3_u32 v29, v138, v139, v29
v_cmp_gt_u32 vcc, 21, v29
s_cbranch_vccnz L_slow42
L_back42:
s_add_u32 m0, s77, 24576
s_add_u32 s98, s73, 49152
buffer_load_dwordx4 v11, s[52:55], s98 offen offset:0 nt lds
s_waitcnt vmcnt(5)
s_add_u32 s98, s73, 52224
buffer_load_dwordx4 v12, s[52:55], s98 offen offset:1024 nt lds
ds_read_b64_tr_b16 v[80:81], v17 offset:16384
ds_read_b64_tr_b16 v[82:83], v17 offset:16896
ds_read_b64_tr_b16 v[84:85], v18 offset:16384
ds_read_b64_tr_b16 v[86:87], v18 offset:16896
ds_read_b64_tr_b16 v[88:89], v19 offset:16384
ds_read_b64_tr_b16 v[90:91], v19 offset:16896
ds_read_b64_tr_b16 v[92:93], v20 offset:16384
ds_read_b64_tr_b16 v[94:95], v20 offset:16896
s_waitcnt vmcnt(5)
s_add_u32 s98, s73, 55296
buffer_load_dwordx4 v11, s[52:55], s98 offen offset:2048 nt lds
s_waitcnt vmcnt(5)
s_add_u32 s98, s73, 58368
buffer_load_dwordx4 v12, s[52:55], s98 offen offset:3072 nt lds
s_waitcnt vmcnt(4)
v_mov_b32 v1, 27
ds_max_u32 v25, v1
ds_read_b64_tr_b16 v[96:97], v17 offset:20480
ds_read_b64_tr_b16 v[98:99], v17 offset:20992
ds_read_b64_tr_b16 v[100:101], v18 offset:20480
ds_read_b64_tr_b16 v[102:103], v18 offset:20992
ds_read_b64_tr_b16 v[104:105], v19 offset:20480
ds_read_b64_tr_b16 v[106:107], v19 offset:20992
ds_read_b64_tr_b16 v[108:109], v20 offset:20480
ds_read_b64_tr_b16 v[110:111], v20 offset:20992
s_waitcnt vmcnt(0)
ds_read_b64_tr_b16 v[112:113], v17 offset:24576
ds_read_b64_tr_b16 v[114:115], v17 offset:25088
ds_read_b64_tr_b16 v[116:117], v18 offset:24576
ds_read_b64_tr_b16 v[118:119], v18 offset:25088
ds_read_b64_tr_b16 v[120:121], v19 offset:24576
ds_read_b64_tr_b16 v[122:123], v19 offset:25088
ds_read_b64_tr_b16 v[124:125], v20 offset:24576
ds_read_b64_tr_b16 v[126:127], v20 offset:25088
L_join:
s_waitcnt lgkmcnt(0)
s_barrier
ds_read_b128 v[32:35], v23 offset:0
ds_read_b128 v[36:39], v23 offset:64
ds_read_b128 v[40:43], v23 offset:128
ds_read_b128 v[44:47], v23 offset:192
s_waitcnt lgkmcnt(3)
v_mfma_f32_16x16x32_bf16 v[48:51], v[32:35], v[64:67], 0
v_mfma_f32_16x16x32_bf16 v[52:55], v[32:35], v[68:71], 0
v_mfma_f32_16x16x32_bf16 v[56:59], v[32:35], v[72:75], 0
v_mfma_f32_16x16x32_bf16 v[60:63], v[32:35], v[76:79], 0
s_waitcnt lgkmcnt(2)
v_mfma_f32_16x16x32_bf16 v[48:51], v[36:39], v[80:83], v[48:51]
v_mfma_f32_16x16x32_bf16 v[52:55], v[36:39], v[84:87], v[52:55]
v_mfma_f32_16x16x32_bf16 v[56:59], v[36:39], v[88:91], v[56:59]
v_mfma_f32_16x16x32_bf16 v[60:63], v[36:39], v[92:95], v[60:63]
s_waitcnt lgkmcnt(1)
v_mfma_f32_16x16x32_bf16 v[48:51], v[40:43], v[96:99], v[48:51]
v_mfma_f32_16x16x32_bf16 v[52:55], v[40:43], v[100:103], v[52:55]
v_mfma_f32_16x16x32_bf16 v[56:59], v[40:43], v[104:107], v[56:59]
v_mfma_f32_16x16x32_bf16 v[60:63], v[40:43], v[108:111], v[60:63]
s_waitcnt lgkmcnt(0)
v_mfma_f32_16x16x32_bf16 v[48:51], v[44:47], v[112:115], v[48:51]
v_mfma_f32_16x16x32_bf16 v[52:55], v[44:47], v[116:119], v[52:55]
v_mfma_f32_16x16x32_bf16 v[56:59], v[44:47], v[120:123], v[56:59]
v_mfma_f32_16x16x32_bf16 v[60:63], v[44:47], v[124:127], v[60:63]
s_nop 5
v_cndmask_b32 v48, v48, v52, s[14:15]
v_cndmask_b32 v49, v49, v53, s[14:15]
v_cndmask_b32 v50, v50, v54, s[14:15]
v_cndmask_b32 v51, v51, v55, s[14:15]
v_cndmask_b32 v56, v56, v60, s[14:15]
v_cndmask_b32 v57, v57, v61, s[14:15]
v_cndmask_b32 v58, v58, v62, s[14:15]
v_cndmask_b32 v59, v59, v63, s[14:15]
v_cvt_pk_bf16_f32 v136, v48, v49
v_cvt_pk_bf16_f32 v137, v50, v51
v_cvt_pk_bf16_f32 v138, v56, v57
v_cvt_pk_bf16_f32 v139, v58, v59
v_and_or_b32 v136, v136, -2, v140
v_and_or_b32 v137, v137, -2, v141
v_and_or_b32 v138, v138, -2, v142
v_and_or_b32 v139, v139, -2, v143
s_mov_b32 exec_hi, 0
buffer_store_dwordx4 v[136:139], v22, s[56:59], s10 offen sc1
s_endpgm
L_slow1:
s_waitcnt vmcnt(0)
v_mov_b32 v1, 7
ds_max_u32 v25, v1
s_mov_b32 s99, 4194304
L_sl1:
ds_read_b32 v29, v25 offset:1024
s_sub_u32 s99, s99, 1
s_cbranch_scc1 L_back1
s_waitcnt lgkmcnt(0)
v_cmp_gt_u32 vcc, 1, v29
s_cbranch_vccz L_back1
s_sleep 1
s_branch L_sl1
L_slow2:
s_waitcnt vmcnt(0)
v_mov_b32 v1, 8
ds_max_u32 v25, v1
s_mov_b32 s99, 4194304
L_sl2:
ds_read_b32 v29, v25 offset:1024
s_sub_u32 s99, s99, 1
s_cbranch_scc1 L_back2
s_waitcnt lgkmcnt(0)
v_cmp_gt_u32 vcc, 2, v29
s_cbranch_vccz L_back2
s_sleep 1
s_branch L_sl2
L_slow3:
s_waitcnt vmcnt(0)
v_mov_b32 v1, 9
ds_max_u32 v25, v1
s_mov_b32 s99, 4194304
L_sl3:
ds_read_b32 v29, v25 offset:1024
s_sub_u32 s99, s99, 1
s_cbranch_scc1 L_back3
s_waitcnt lgkmcnt(0)
v_cmp_gt_u32 vcc, 3, v29
s_cbranch_vccz L_back3
s_sleep 1
s_branch L_sl3
L_slow4:
s_waitcnt vmcnt(0)
v_mov_b32 v1, 10
ds_max_u32 v25, v1
s_mov_b32 s99, 4194304
L_sl4:
ds_read_b32 v29, v25 offset:1024
s_sub_u32 s99, s99, 1
s_cbranch_scc1 L_back4
s_waitcnt lgkmcnt(0)
v_cmp_gt_u32 vcc, 4, v29
s_cbranch_vccz L_back4
s_sleep 1
s_branch L_sl4
L_slow5:
s_waitcnt vmcnt(0)
v_mov_b32 v1, 11
ds_max_u32 v25, v1
s_mov_b32 s99, 4194304
L_sl5:
ds_read_b32 v29, v25 offset:1024
s_sub_u32 s99, s99, 1
s_cbranch_scc1 L_back5
s_waitcnt lgkmcnt(0)
v_cmp_gt_u32 vcc, 5, v29
s_cbranch_vccz L_back5
s_sleep 1
s_branch L_sl5
L_slow6:
s_waitcnt vmcnt(0)
v_mov_b32 v1, 12
ds_max_u32 v25, v1
s_mov_b32 s99, 4194304
L_sl6:
ds_read_b32 v29, v25 offset:1024
s_sub_u32 s99, s99, 1
s_cbranch_scc1 L_back6
s_waitcnt lgkmcnt(0)
v_cmp_gt_u32 vcc, 6, v29
s_cbranch_vccz L_back6
s_sleep 1
s_branch L_sl6
L_slow7:
s_waitcnt vmcnt(0)
v_mov_b32 v1, 13
ds_max_u32 v25, v1
s_mov_b32 s99, 4194304
L_sl7:
ds_read_b32 v29, v25 offset:1024
s_sub_u32 s99, s99, 1
s_cbranch_scc1 L_back7
s_waitcnt lgkmcnt(0)
v_cmp_gt_u32 vcc, 7, v29
s_cbranch_vccz L_back7
s_sleep 1
s_branch L_sl7
L_slow8:
s_waitcnt vmcnt(0)
v_mov_b32 v1, 14
ds_max_u32 v25, v1
s_mov_b32 s99, 4194304
L_sl8:
ds_read_b32 v29, v25 offset:1024
s_sub_u32 s99, s99, 1
s_cbranch_scc1 L_back8
s_waitcnt lgkmcnt(0)
v_cmp_gt_u32 vcc, 8, v29
s_cbranch_vccz L_back8
s_sleep 1
s_branch L_sl8
L_slow9:
s_waitcnt vmcnt(0)
v_mov_b32 v1, 15
ds_max_u32 v25, v1
s_mov_b32 s99, 4194304
L_sl9:
ds_read_b32 v29, v25 offset:1024
s_sub_u32 s99, s99, 1
s_cbranch_scc1 L_back9
s_waitcnt lgkmcnt(0)
v_cmp_gt_u32 vcc, 9, v29
s_cbranch_vccz L_back9
s_sleep 1
s_branch L_sl9
L_slow10:
s_waitcnt vmcnt(0)
v_mov_b32 v1, 16
ds_max_u32 v25, v1
s_mov_b32 s99, 4194304
L_sl10:
ds_read_b32 v29, v25 offset:1024
s_sub_u32 s99, s99, 1
s_cbranch_scc1 L_back10
s_waitcnt lgkmcnt(0)
v_cmp_gt_u32 vcc, 10, v29
s_cbranch_vccz L_back10
s_sleep 1
s_branch L_sl10
L_slow11:
s_waitcnt vmcnt(0)
v_mov_b32 v1, 17
ds_max_u32 v25, v1
s_mov_b32 s99, 4194304
L_sl11:
ds_read_b32 v29, v25 offset:1024
s_sub_u32 s99, s99, 1
s_cbranch_scc1 L_back11
s_waitcnt lgkmcnt(0)
v_cmp_gt_u32 vcc, 11, v29
s_cbranch_vccz L_back11
s_sleep 1
s_branch L_sl11
L_slow12:
s_waitcnt vmcnt(0)
v_mov_b32 v1, 18
ds_max_u32 v25, v1
s_mov_b32 s99, 4194304
L_sl12:
ds_read_b32 v29, v25 offset:1024
s_sub_u32 s99, s99, 1
s_cbranch_scc1 L_back12
s_waitcnt lgkmcnt(0)
v_cmp_gt_u32 vcc, 12, v29
s_cbranch_vccz L_back12
s_sleep 1
s_branch L_sl12
L_slow13:
s_waitcnt vmcnt(0)
v_mov_b32 v1, 19
ds_max_u32 v25, v1
s_mov_b32 s99, 4194304
L_sl13:
ds_read_b32 v29, v25 offset:1024
s_sub_u32 s99, s99, 1
s_cbranch_scc1 L_back13
s_waitcnt lgkmcnt(0)
v_cmp_gt_u32 vcc, 13, v29
s_cbranch_vccz L_back13
s_sleep 1
s_branch L_sl13
L_slow14:
s_waitcnt vmcnt(0)
v_mov_b32 v1, 20
ds_max_u32 v25, v1
s_mov_b32 s99, 4194304
L_sl14:
ds_read_b32 v29, v25 offset:1024
s_sub_u32 s99, s99, 1
s_cbranch_scc1 L_back14
s_waitcnt lgkmcnt(0)
v_cmp_gt_u32 vcc, 14, v29
s_cbranch_vccz L_back14
s_sleep 1
s_branch L_sl14
L_slow15:
s_waitcnt vmcnt(0)
v_mov_b32 v1, 21
ds_max_u32 v25, v1
s_mov_b32 s99, 4194304
L_sl15:
ds_read_b128 v[136:139], v26 offset:1024
s_sub_u32 s99, s99, 1
s_cbranch_scc1 L_back15
s_waitcnt lgkmcnt(0)
v_min_u32 v29, v136, v137
v_min3_u32 v29, v138, v139, v29
v_cmp_gt_u32 vcc, 15, v29
s_cbranch_vccz L_back15
s_sleep 1
s_branch L_sl15
L_slow16:
s_waitcnt vmcnt(0)
v_mov_b32 v1, 22
ds_max_u32 v25, v1
s_mov_b32 s99, 4194304
L_sl16:
ds_read_b128 v[136:139], v26 offset:1024
s_sub_u32 s99, s99, 1
s_cbranch_scc1 L_back16
s_waitcnt lgkmcnt(0)
v_min_u32 v29, v136, v137
v_min3_u32 v29, v138, v139, v29
v_cmp_gt_u32 vcc, 16, v29
s_cbranch_vccz L_back16
s_sleep 1
s_branch L_sl16
L_slow17:
s_waitcnt vmcnt(0)
v_mov_b32 v1, 23
ds_max_u32 v25, v1
s_mov_b32 s99, 4194304
L_sl17:
ds_read_b128 v[136:139], v26 offset:1024
s_sub_u32 s99, s99, 1
s_cbranch_scc1 L_back17
s_waitcnt lgkmcnt(0)
v_min_u32 v29, v136, v137
v_min3_u32 v29, v138, v139, v29
v_cmp_gt_u32 vcc, 17, v29
s_cbranch_vccz L_back17
s_sleep 1
s_branch L_sl17
L_slow18:
s_waitcnt vmcnt(0)
v_mov_b32 v1, 24
ds_max_u32 v25, v1
s_mov_b32 s99, 4194304
L_sl18:
ds_read_b128 v[136:139], v26 offset:1024
s_sub_u32 s99, s99, 1
s_cbranch_scc1 L_back18
s_waitcnt lgkmcnt(0)
v_min_u32 v29, v136, v137
v_min3_u32 v29, v138, v139, v29
v_cmp_gt_u32 vcc, 18, v29
s_cbranch_vccz L_back18
s_sleep 1
s_branch L_sl18
L_slow19:
s_waitcnt vmcnt(0)
v_mov_b32 v1, 24
ds_max_u32 v25, v1
s_mov_b32 s99, 4194304
L_sl19:
ds_read_b128 v[136:139], v26 offset:1024
s_sub_u32 s99, s99, 1
s_cbranch_scc1 L_back19
s_waitcnt lgkmcnt(0)
v_min_u32 v29, v136, v137
v_min3_u32 v29, v138, v139, v29
v_cmp_gt_u32 vcc, 19, v29
s_cbranch_vccz L_back19
s_sleep 1
s_branch L_sl19
L_slow20:
s_waitcnt vmcnt(0)
v_mov_b32 v1, 24
ds_max_u32 v25, v1
s_mov_b32 s99, 4194304
L_sl20:
ds_read_b128 v[136:139], v26 offset:1024
s_sub_u32 s99, s99, 1
s_cbranch_scc1 L_back20
s_waitcnt lgkmcnt(0)
v_min_u32 v29, v136, v137
v_min3_u32 v29, v138, v139, v29
v_cmp_gt_u32 vcc, 20, v29
s_cbranch_vccz L_back20
s_sleep 1
s_branch L_sl20
L_slow21:
s_waitcnt vmcnt(0)
v_mov_b32 v1, 24
ds_max_u32 v25, v1
s_mov_b32 s99, 4194304
L_sl21:
ds_read_b128 v[136:139], v26 offset:1024
s_sub_u32 s99, s99, 1
s_cbranch_scc1 L_back21
s_waitcnt lgkmcnt(0)
v_min_u32 v29, v136, v137
v_min3_u32 v29, v138, v139, v29
v_cmp_gt_u32 vcc, 21, v29
s_cbranch_vccz L_back21
s_sleep 1
s_branch L_sl21
L_deep:
s_waitcnt vmcnt(7)
s_add_u32 m0, s77, 8192
s_add_u32 s98, s76, 0
s_and_b32 s98, s98, 32767
s_add_u32 s98, s98, s74
buffer_load_dwordx4 v5, s[36:39], s98 offen offset:0 nt lds
s_waitcnt vmcnt(7)
buffer_load_dwordx4 v6, s[36:39], s98 offen offset:1024 nt lds
s_waitcnt vmcnt(7)
buffer_load_dwordx4 v7, s[36:39], s98 offen offset:2048 nt lds
s_waitcnt vmcnt(7)
s_barrier
v_mov_b32 v1, 1
ds_max_u32 v25, v1
buffer_load_dwordx4 v8, s[36:39], s98 offen offset:3072 nt lds
s_waitcnt vmcnt(7)
s_add_u32 m0, s77, 12288
s_add_u32 s98, s72, 524288
buffer_load_dwordx4 v9, s[32:35], s98 offen offset:0 nt lds
s_waitcnt vmcnt(7)
s_add_u32 s98, s72, 588800
buffer_load_dwordx4 v10, s[32:35], s98 offen offset:1024 nt lds
s_waitcnt vmcnt(7)
s_add_u32 s98, s72, 653312
buffer_load_dwordx4 v9, s[32:35], s98 offen offset:2048 nt lds
s_waitcnt vmcnt(7)
v_mov_b32 v1, 2
ds_max_u32 v25, v1
s_add_u32 s98, s72, 717824
buffer_load_dwordx4 v10, s[32:35], s98 offen offset:3072 nt lds
s_waitcnt vmcnt(7)
s_add_u32 m0, s77, 16384
s_add_u32 s98, s76, 16384
s_and_b32 s98, s98, 32767
s_add_u32 s98, s98, s74
buffer_load_dwordx4 v5, s[36:39], s98 offen offset:0 nt lds
s_waitcnt vmcnt(7)
buffer_load_dwordx4 v6, s[36:39], s98 offen offset:1024 nt lds
s_waitcnt vmcnt(7)
buffer_load_dwordx4 v7, s[36:39], s98 offen offset:2048 nt lds
s_waitcnt vmcnt(7)
v_mov_b32 v1, 3
ds_max_u32 v25, v1
buffer_load_dwordx4 v8, s[36:39], s98 offen offset:3072 nt lds
s_waitcnt vmcnt(7)
s_add_u32 m0, s77, 20480
s_add_u32 s98, s72, 786432
buffer_load_dwordx4 v9, s[32:35], s98 offen offset:0 nt lds
s_waitcnt vmcnt(7)
s_add_u32 s98, s72, 850944
buffer_load_dwordx4 v10, s[32:35], s98 offen offset:1024 nt lds
s_waitcnt vmcnt(7)
s_add_u32 s98, s72, 915456
buffer_load_dwordx4 v9, s[32:35], s98 offen offset:2048 nt lds
s_waitcnt vmcnt(7)
v_mov_b32 v1, 4
ds_max_u32 v25, v1
s_add_u32 s98, s72, 979968
buffer_load_dwordx4 v10, s[32:35], s98 offen offset:3072 nt lds
s_waitcnt vmcnt(7)
s_add_u32 m0, s77, 24576
s_add_u32 s98, s76, 0
s_and_b32 s98, s98, 131071
s_add_u32 s98, s98, s75
buffer_load_dwordx4 v5, s[44:47], s98 offen offset:0 nt lds
s_waitcnt vmcnt(7)
buffer_load_dwordx4 v6, s[44:47], s98 offen offset:1024 nt lds
s_waitcnt vmcnt(7)
buffer_load_dwordx4 v7, s[44:47], s98 offen offset:2048 nt lds
s_waitcnt vmcnt(7)
v_mov_b32 v1, 5
ds_max_u32 v25, v1
buffer_load_dwordx4 v8, s[44:47], s98 offen offset:3072 nt lds
ds_read_b32 v29, v25 offset:1024
s_waitcnt vmcnt(7)
s_waitcnt lgkmcnt(0)
v_cmp_gt_u32 vcc, 1, v29
s_cbranch_vccnz L_slow1
L_back1:
s_add_u32 m0, s77, 0
s_add_u32 s98, s76, 16384
s_and_b32 s98, s98, 131071
s_add_u32 s98, s98, s75
buffer_load_dwordx4 v5, s[44:47], s98 offen offset:0 nt lds
s_waitcnt vmcnt(7)
buffer_load_dwordx4 v6, s[44:47], s98 offen offset:1024 nt lds
s_waitcnt vmcnt(7)
buffer_load_dwordx4 v7, s[44:47], s98 offen offset:2048 nt lds
s_waitcnt vmcnt(7)
v_mov_b32 v1, 6
ds_max_u32 v25, v1
buffer_load_dwordx4 v8, s[44:47], s98 offen offset:3072 nt lds
ds_read_b32 v29, v25 offset:1024
s_lshr_b32 s73, s6, 2
s_lshl_b32 s73, s73, 20
s_and_b32 s13, s6, 3
s_lshl_b32 s13, s13, 16
s_add_u32 s73, s73, s13
s_lshl_b32 s13, s7, 9
s_add_u32 s73, s73, s13
s_lshl_b32 s13, s3, 7
s_add_u32 s73, s73, s13
v_lshrrev_b32 v1, 3, v0
v_lshlrev_b32 v1, 12, v1
v_and_b32 v2, 7, v0
v_lshl_add_u32 v22, v2, 4, v1
s_lshl_b32 s10, s101, 18
s_lshl_b32 s11, s7, 16
s_add_u32 s10, s10, s11
s_lshl_b32 s11, s3, 14
s_add_u32 s10, s10, s11
s_lshl_b32 s11, s6, 7
s_add_u32 s10, s10, s11
s_add_u32 s10, s10, 1572864
v_bfe_u32 v1, v0, 3, 2
v_lshlrev_b32 v1, 5, v1
v_and_b32 v2, 3, v0
v_lshl_add_u32 v1, v2, 3, v1
v_bfe_u32 v2, v0, 2, 2
v_lshl_add_u32 v1, v2, 7, v1
v_lshrrev_b32 v2, 4, v0
v_lshl_add_u32 v1, v2, 10, v1
v_add_u32 v17, s77, v1
v_xor_b32 v18, 32, v17
v_xor_b32 v19, 64, v17
v_xor_b32 v20, 96, v17
s_mov_b32 s14, 0xf0f0f0f0
s_mov_b32 s15, s14
s_mov_b32 s16, 0xff00ff00
s_mov_b32 s17, s16
v_and_b32 v1, 3, v0
v_mul_u32_u24 v1, 272, v1
v_lshrrev_b32 v2, 4, v0
v_lshl_add_u32 v1, v2, 4, v1
v_add_u32 v23, 144640, v1
v_mov_b32 v24, 145728
s_mov_b32 s18, 0xffffff00
s_mov_b32 s14, 0xffff0000
s_mov_b32 s15, s14
s_mov_b32 s16, 0
s_mov_b32 s17, -1
s_waitcnt vmcnt(7)
s_waitcnt lgkmcnt(0)
v_cmp_gt_u32 vcc, 2, v29
s_cbranch_vccnz L_slow2
L_back2:
s_add_u32 m0, s77, 4096
s_add_u32 s98, s76, 32768
s_and_b32 s98, s98, 131071
s_add_u32 s98, s98, s75
buffer_load_dwordx4 v5, s[44:47], s98 offen offset:0 nt lds
s_waitcnt vmcnt(7)
buffer_load_dwordx4 v6, s[44:47], s98 offen offset:1024 nt lds
s_waitcnt vmcnt(7)
buffer_load_dwordx4 v7, s[44:47], s98 offen offset:2048 nt lds
s_waitcnt vmcnt(7)
v_mov_b32 v1, 7
ds_max_u32 v25, v1
buffer_load_dwordx4 v8, s[44:47], s98 offen offset:3072 nt lds
ds_read_b32 v29, v25 offset:1024
s_waitcnt vmcnt(7)
s_waitcnt lgkmcnt(0)
v_cmp_gt_u32 vcc, 3, v29
s_cbranch_vccnz L_slow3
L_back3:
s_add_u32 m0, s77, 8192
s_add_u32 s98, s76, 49152
s_and_b32 s98, s98, 131071
s_add_u32 s98, s98, s75
buffer_load_dwordx4 v5, s[44:47], s98 offen offset:0 nt lds
s_waitcnt vmcnt(7)
buffer_load_dwordx4 v6, s[44:47], s98 offen offset:1024 nt lds
s_waitcnt vmcnt(7)
buffer_load_dwordx4 v7, s[44:47], s98 offen offset:2048 nt lds
s_waitcnt vmcnt(7)
v_mov_b32 v1, 8
ds_max_u32 v25, v1
buffer_load_dwordx4 v8, s[44:47], s98 offen offset:3072 nt lds
ds_read_b32 v29, v25 offset:1024
s_waitcnt vmcnt(7)
s_waitcnt lgkmcnt(0)
v_cmp_gt_u32 vcc, 4, v29
s_cbranch_vccnz L_slow4
L_back4:
s_add_u32 m0, s77, 12288
s_add_u32 s98, s76, 65536
s_and_b32 s98, s98, 131071
s_add_u32 s98, s98, s75
buffer_load_dwordx4 v5, s[44:47], s98 offen offset:0 nt lds
s_waitcnt vmcnt(7)
buffer_load_dwordx4 v6, s[44:47], s98 offen offset:1024 nt lds
s_waitcnt vmcnt(7)
buffer_load_dwordx4 v7, s[44:47], s98 offen offset:2048 nt lds
s_waitcnt vmcnt(7)
v_mov_b32 v1, 9
ds_max_u32 v25, v1
buffer_load_dwordx4 v8, s[44:47], s98 offen offset:3072 nt lds
ds_read_b32 v29, v25 offset:1024
s_waitcnt vmcnt(7)
s_waitcnt lgkmcnt(0)
v_cmp_gt_u32 vcc, 5, v29
s_cbranch_vccnz L_slow5
L_back5:
s_add_u32 m0, s77, 16384
s_add_u32 s98, s76, 81920
s_and_b32 s98, s98, 131071
s_add_u32 s98, s98, s75
buffer_load_dwordx4 v5, s[44:47], s98 offen offset:0 nt lds
s_waitcnt vmcnt(7)
buffer_load_dwordx4 v6, s[44:47], s98 offen offset:1024 nt lds
s_waitcnt vmcnt(7)
buffer_load_dwordx4 v7, s[44:47], s98 offen offset:2048 nt lds
s_waitcnt vmcnt(7)
v_mov_b32 v1, 10
ds_max_u32 v25, v1
buffer_load_dwordx4 v8, s[44:47], s98 offen offset:3072 nt lds
ds_read_b32 v29, v25 offset:1024
s_waitcnt vmcnt(7)
s_waitcnt lgkmcnt(0)
v_cmp_gt_u32 vcc, 6, v29
s_cbranch_vccnz L_slow6
L_back6:
s_add_u32 m0, s77, 20480
s_add_u32 s98, s76, 98304
s_and_b32 s98, s98, 131071
s_add_u32 s98, s98, s75
buffer_load_dwordx4 v5, s[44:47], s98 offen offset:0 nt lds
s_waitcnt vmcnt(7)
buffer_load_dwordx4 v6, s[44:47], s98 offen offset:1024 nt lds
s_waitcnt vmcnt(7)
buffer_load_dwordx4 v7, s[44:47], s98 offen offset:2048 nt lds
s_waitcnt vmcnt(7)
v_mov_b32 v1, 11
ds_max_u32 v25, v1
buffer_load_dwordx4 v8, s[44:47], s98 offen offset:3072 nt lds
ds_read_b32 v29, v25 offset:1024
s_waitcnt vmcnt(7)
s_waitcnt lgkmcnt(0)
v_cmp_gt_u32 vcc, 7, v29
s_cbranch_vccnz L_slow7
L_back7:
s_add_u32 m0, s77, 24576
s_add_u32 s98, s76, 114688
s_and_b32 s98, s98, 131071
s_add_u32 s98, s98, s75
buffer_load_dwordx4 v5, s[44:47], s98 offen offset:0 nt lds
s_waitcnt vmcnt(7)
buffer_load_dwordx4 v6, s[44:47], s98 offen offset:1024 nt lds
s_waitcnt vmcnt(7)
buffer_load_dwordx4 v7, s[44:47], s98 offen offset:2048 nt lds
s_waitcnt vmcnt(7)
v_mov_b32 v1, 12
ds_max_u32 v25, v1
buffer_load_dwordx4 v8, s[44:47], s98 offen offset:3072 nt lds
ds_read_b32 v29, v25 offset:1024
s_waitcnt vmcnt(7)
s_waitcnt lgkmcnt(0)
v_cmp_gt_u32 vcc, 8, v29
s_cbranch_vccnz L_slow8
L_back8:
s_add_u32 m0, s77, 0
s_add_u32 s98, s76, 0
s_and_b32 s98, s98, 32767
s_add_u32 s98, s98, s74
buffer_load_dwordx4 v5, s[40:43], s98 offen offset:0 nt lds
s_waitcnt vmcnt(7)
buffer_load_dwordx4 v6, s[40:43], s98 offen offset:1024 nt lds
s_waitcnt vmcnt(7)
buffer_load_dwordx4 v7, s[40:43], s98 offen offset:2048 nt lds
s_waitcnt vmcnt(7)
v_mov_b32 v1, 13
ds_max_u32 v25, v1
buffer_load_dwordx4 v8, s[40:43], s98 offen offset:3072 nt lds
ds_read_b32 v29, v25 offset:1024
s_waitcnt vmcnt(7)
s_waitcnt lgkmcnt(0)
v_cmp_gt_u32 vcc, 9, v29
s_cbranch_vccnz L_slow9
L_back9:
s_add_u32 m0, s77, 4096
s_add_u32 s98, s76, 16384
s_and_b32 s98, s98, 32767
s_add_u32 s98, s98, s74
buffer_load_dwordx4 v5, s[40:43], s98 offen offset:0 nt lds
s_waitcnt vmcnt(7)
buffer_load_dwordx4 v6, s[40:43], s98 offen offset:1024 nt lds
s_waitcnt vmcnt(7)
buffer_load_dwordx4 v7, s[40:43], s98 offen offset:2048 nt lds
s_waitcnt vmcnt(7)
v_mov_b32 v1, 14
ds_max_u32 v25, v1
buffer_load_dwordx4 v8, s[40:43], s98 offen offset:3072 nt lds
ds_read_b32 v29, v25 offset:1024
s_waitcnt vmcnt(7)
s_waitcnt lgkmcnt(0)
v_cmp_gt_u32 vcc, 10, v29
s_cbranch_vccnz L_slow10
L_back10:
s_add_u32 m0, s77, 8192
s_add_u32 s98, s76, 0
s_and_b32 s98, s98, 131071
s_add_u32 s98, s98, s75
buffer_load_dwordx4 v5, s[48:51], s98 offen offset:0 nt lds
s_waitcnt vmcnt(7)
buffer_load_dwordx4 v6, s[48:51], s98 offen offset:1024 nt lds
s_waitcnt vmcnt(7)
buffer_load_dwordx4 v7, s[48:51], s98 offen offset:2048 nt lds
s_waitcnt vmcnt(7)
v_mov_b32 v1, 15
ds_max_u32 v25, v1
buffer_load_dwordx4 v8, s[48:51], s98 offen offset:3072 nt lds
ds_read_b32 v29, v25 offset:1024
s_waitcnt vmcnt(7)
s_waitcnt lgkmcnt(0)
v_cmp_gt_u32 vcc, 11, v29
s_cbranch_vccnz L_slow11
L_back11:
s_add_u32 m0, s77, 12288
s_add_u32 s98, s76, 16384
s_and_b32 s98, s98, 131071
s_add_u32 s98, s98, s75
buffer_load_dwordx4 v5, s[48:51], s98 offen offset:0 nt lds
s_waitcnt vmcnt(7)
buffer_load_dwordx4 v6, s[48:51], s98 offen offset:1024 nt lds
s_waitcnt vmcnt(7)
buffer_load_dwordx4 v7, s[48:51], s98 offen offset:2048 nt lds
s_waitcnt vmcnt(7)
v_mov_b32 v1, 16
ds_max_u32 v25, v1
buffer_load_dwordx4 v8, s[48:51], s98 offen offset:3072 nt lds
ds_read_b32 v29, v25 offset:1024
s_waitcnt vmcnt(7)
s_waitcnt lgkmcnt(0)
v_cmp_gt_u32 vcc, 12, v29
s_cbranch_vccnz L_slow12
L_back12:
s_add_u32 m0, s77, 16384
s_add_u32 s98, s76, 32768
s_and_b32 s98, s98, 131071
s_add_u32 s98, s98, s75
buffer_load_dwordx4 v5, s[48:51], s98 offen offset:0 nt lds
s_waitcnt vmcnt(7)
buffer_load_dwordx4 v6, s[48:51], s98 offen offset:1024 nt lds
s_waitcnt vmcnt(7)
buffer_load_dwordx4 v7, s[48:51], s98 offen offset:2048 nt lds
s_waitcnt vmcnt(7)
v_mov_b32 v1, 17
ds_max_u32 v25, v1
buffer_load_dwordx4 v8, s[48:51], s98 offen offset:3072 nt lds
ds_read_b32 v29, v25 offset:1024
s_waitcnt vmcnt(7)
s_waitcnt lgkmcnt(0)
v_cmp_gt_u32 vcc, 13, v29
s_cbranch_vccnz L_slow13
L_back13:
s_add_u32 m0, s77, 20480
s_add_u32 s98, s76, 49152
s_and_b32 s98, s98, 131071
s_add_u32 s98, s98, s75
buffer_load_dwordx4 v5, s[48:51], s98 offen offset:0 nt lds
s_waitcnt vmcnt(7)
buffer_load_dwordx4 v6, s[48:51], s98 offen offset:1024 nt lds
s_waitcnt vmcnt(7)
buffer_load_dwordx4 v7, s[48:51], s98 offen offset:2048 nt lds
s_waitcnt vmcnt(7)
v_mov_b32 v1, 18
ds_max_u32 v25, v1
buffer_load_dwordx4 v8, s[48:51], s98 offen offset:3072 nt lds
ds_read_b32 v29, v25 offset:1024
s_waitcnt vmcnt(7)
s_waitcnt lgkmcnt(0)
v_cmp_gt_u32 vcc, 14, v29
s_cbranch_vccnz L_slow14
L_back14:
s_add_u32 m0, s77, 24576
s_add_u32 s98, s76, 65536
s_and_b32 s98, s98, 131071
s_add_u32 s98, s98, s75
buffer_load_dwordx4 v5, s[48:51], s98 offen offset:0 nt lds
s_waitcnt vmcnt(7)
buffer_load_dwordx4 v6, s[48:51], s98 offen offset:1024 nt lds
s_waitcnt vmcnt(7)
buffer_load_dwordx4 v7, s[48:51], s98 offen offset:2048 nt lds
s_waitcnt vmcnt(7)
v_mov_b32 v1, 19
ds_max_u32 v25, v1
buffer_load_dwordx4 v8, s[48:51], s98 offen offset:3072 nt lds
ds_read_b128 v[136:139], v26 offset:1024
s_waitcnt vmcnt(7)
s_waitcnt lgkmcnt(0)
v_min_u32 v29, v136, v137
v_min3_u32 v29, v138, v139, v29
v_cmp_gt_u32 vcc, 15, v29
s_cbranch_vccnz L_slow15
L_back15:
s_add_u32 m0, s77, 0
s_add_u32 s98, s76, 81920
s_and_b32 s98, s98, 131071
s_add_u32 s98, s98, s75
buffer_load_dwordx4 v5, s[48:51], s98 offen offset:0 nt lds
s_waitcnt vmcnt(7)
buffer_load_dwordx4 v6, s[48:51], s98 offen offset:1024 nt lds
s_waitcnt vmcnt(7)
buffer_load_dwordx4 v7, s[48:51], s98 offen offset:2048 nt lds
s_waitcnt vmcnt(7)
v_mov_b32 v1, 20
ds_max_u32 v25, v1
buffer_load_dwordx4 v8, s[48:51], s98 offen offset:3072 nt lds
ds_read_b128 v[136:139], v26 offset:1024
s_waitcnt vmcnt(7)
s_waitcnt lgkmcnt(0)
v_min_u32 v29, v136, v137
v_min3_u32 v29, v138, v139, v29
v_cmp_gt_u32 vcc, 16, v29
s_cbranch_vccnz L_slow16
L_back16:
s_add_u32 m0, s77, 4096
s_add_u32 s98, s76, 98304
s_and_b32 s98, s98, 131071
s_add_u32 s98, s98, s75
buffer_load_dwordx4 v5, s[48:51], s98 offen offset:0 nt lds
s_waitcnt vmcnt(7)
buffer_load_dwordx4 v6, s[48:51], s98 offen offset:1024 nt lds
s_waitcnt vmcnt(7)
buffer_load_dwordx4 v7, s[48:51], s98 offen offset:2048 nt lds
s_waitcnt vmcnt(7)
v_mov_b32 v1, 21
ds_max_u32 v25, v1
buffer_load_dwordx4 v8, s[48:51], s98 offen offset:3072 nt lds
ds_read_b128 v[136:139], v26 offset:1024
ds_read_b32 v144, v24
s_waitcnt vmcnt(7)
s_waitcnt lgkmcnt(0)
v_min_u32 v29, v136, v137
v_min3_u32 v29, v138, v139, v29
v_cmp_gt_u32 vcc, 17, v29
s_cbranch_vccnz L_slow17
L_back17:
s_add_u32 m0, s77, 8192
s_add_u32 s98, s76, 114688
s_and_b32 s98, s98, 131071
s_add_u32 s98, s98, s75
buffer_load_dwordx4 v5, s[48:51], s98 offen offset:0 nt lds
s_waitcnt vmcnt(7)
buffer_load_dwordx4 v6, s[48:51], s98 offen offset:1024 nt lds
s_waitcnt vmcnt(7)
buffer_load_dwordx4 v7, s[48:51], s98 offen offset:2048 nt lds
s_waitcnt vmcnt(7)
v_mov_b32 v1, 22
ds_max_u32 v25, v1
buffer_load_dwordx4 v8, s[48:51], s98 offen offset:3072 nt lds
ds_read_b128 v[136:139], v26 offset:1024
s_waitcnt vmcnt(7)
s_waitcnt lgkmcnt(0)
v_min_u32 v29, v136, v137
v_min3_u32 v29, v138, v139, v29
v_cmp_gt_u32 vcc, 18, v29
s_cbranch_vccnz L_slow18
L_back18:
s_add_u32 m0, s77, 12288
s_add_u32 s98, s73, 0
buffer_load_dwordx4 v11, s[52:55], s98 offen offset:0 nt lds
s_waitcnt vmcnt(7)
s_add_u32 s98, s73, 3072
buffer_load_dwordx4 v12, s[52:55], s98 offen offset:1024 nt lds
s_waitcnt vmcnt(7)
s_add_u32 s98, s73, 6144
buffer_load_dwordx4 v11, s[52:55], s98 offen offset:2048 nt lds
s_waitcnt vmcnt(7)
v_mov_b32 v1, 23
ds_max_u32 v25, v1
s_add_u32 s98, s73, 9216
buffer_load_dwordx4 v12, s[52:55], s98 offen offset:3072 nt lds
ds_read_b128 v[136:139], v26 offset:1024
s_waitcnt lgkmcnt(0)
v_and_b32 v2, 7, v0
v_lshlrev_b32 v2, 2, v2
v_lshrrev_b32 v2, v2, v144
v_bfe_u32 v140, v2, 0, 1
v_bfe_u32 v141, v2, 1, 1
v_bfe_u32 v142, v2, 2, 1
v_bfe_u32 v143, v2, 3, 1
s_waitcnt vmcnt(7)
s_waitcnt lgkmcnt(0)
v_min_u32 v29, v136, v137
v_min3_u32 v29, v138, v139, v29
v_cmp_gt_u32 vcc, 19, v29
s_cbranch_vccnz L_slow19
L_back19:
s_add_u32 m0, s77, 16384
s_add_u32 s98, s73, 16384
buffer_load_dwordx4 v11, s[52:55], s98 offen offset:0 nt lds
s_waitcnt vmcnt(7)
s_add_u32 s98, s73, 19456
buffer_load_dwordx4 v12, s[52:55], s98 offen offset:1024 nt lds
s_waitcnt vmcnt(7)
s_add_u32 s98, s73, 22528
buffer_load_dwordx4 v11, s[52:55], s98 offen offset:2048 nt lds
s_waitcnt vmcnt(7)
v_mov_b32 v1, 24
ds_max_u32 v25, v1
s_add_u32 s98, s73, 25600
buffer_load_dwordx4 v12, s[52:55], s98 offen offset:3072 nt lds
ds_read_b128 v[136:139], v26 offset:1024
s_waitcnt vmcnt(7)
s_waitcnt lgkmcnt(0)
v_min_u32 v29, v136, v137
v_min3_u32 v29, v138, v139, v29
v_cmp_gt_u32 vcc, 20, v29
s_cbranch_vccnz L_slow20
L_back20:
s_add_u32 m0, s77, 20480
s_add_u32 s98, s73, 32768
buffer_load_dwordx4 v11, s[52:55], s98 offen offset:0 nt lds
s_waitcnt vmcnt(7)
s_add_u32 s98, s73, 35840
buffer_load_dwordx4 v12, s[52:55], s98 offen offset:1024 nt lds
s_waitcnt vmcnt(7)
s_add_u32 s98, s73, 38912
buffer_load_dwordx4 v11, s[52:55], s98 offen offset:2048 nt lds
s_waitcnt vmcnt(7)
s_add_u32 s98, s73, 41984
buffer_load_dwordx4 v12, s[52:55], s98 offen offset:3072 nt lds
ds_read_b128 v[136:139], v26 offset:1024
ds_read_b64_tr_b16 v[64:65], v17 offset:12288
ds_read_b64_tr_b16 v[66:67], v17 offset:12800
ds_read_b64_tr_b16 v[68:69], v18 offset:12288
ds_read_b64_tr_b16 v[70:71], v18 offset:12800
ds_read_b64_tr_b16 v[72:73], v19 offset:12288
ds_read_b64_tr_b16 v[74:75], v19 offset:12800
ds_read_b64_tr_b16 v[76:77], v20 offset:12288
ds_read_b64_tr_b16 v[78:79], v20 offset:12800
s_waitcnt vmcnt(7)
s_waitcnt lgkmcnt(0)
v_min_u32 v29, v136, v137
v_min3_u32 v29, v138, v139, v29
v_cmp_gt_u32 vcc, 21, v29
s_cbranch_vccnz L_slow21
L_back21:
s_add_u32 m0, s77, 24576
s_add_u32 s98, s73, 49152
buffer_load_dwordx4 v11, s[52:55], s98 offen offset:0 nt lds
s_waitcnt vmcnt(7)
s_add_u32 s98, s73, 52224
buffer_load_dwordx4 v12, s[52:55], s98 offen offset:1024 nt lds
s_waitcnt vmcnt(7)
s_add_u32 s98, s73, 55296
buffer_load_dwordx4 v11, s[52:55], s98 offen offset:2048 nt lds
s_waitcnt vmcnt(7)
s_add_u32 s98, s73, 58368
buffer_load_dwordx4 v12, s[52:55], s98 offen offset:3072 nt lds
ds_read_b64_tr_b16 v[80:81], v17 offset:16384
ds_read_b64_tr_b16 v[82:83], v17 offset:16896
ds_read_b64_tr_b16 v[84:85], v18 offset:16384
ds_read_b64_tr_b16 v[86:87], v18 offset:16896
ds_read_b64_tr_b16 v[88:89], v19 offset:16384
ds_read_b64_tr_b16 v[90:91], v19 offset:16896
ds_read_b64_tr_b16 v[92:93], v20 offset:16384
ds_read_b64_tr_b16 v[94:95], v20 offset:16896
s_waitcnt vmcnt(4)
v_mov_b32 v1, 27
ds_max_u32 v25, v1
ds_read_b64_tr_b16 v[96:97], v17 offset:20480
ds_read_b64_tr_b16 v[98:99], v17 offset:20992
ds_read_b64_tr_b16 v[100:101], v18 offset:20480
ds_read_b64_tr_b16 v[102:103], v18 offset:20992
ds_read_b64_tr_b16 v[104:105], v19 offset:20480
ds_read_b64_tr_b16 v[106:107], v19 offset:20992
ds_read_b64_tr_b16 v[108:109], v20 offset:20480
ds_read_b64_tr_b16 v[110:111], v20 offset:20992
s_waitcnt vmcnt(0)
ds_read_b64_tr_b16 v[112:113], v17 offset:24576
ds_read_b64_tr_b16 v[114:115], v17 offset:25088
ds_read_b64_tr_b16 v[116:117], v18 offset:24576
ds_read_b64_tr_b16 v[118:119], v18 offset:25088
ds_read_b64_tr_b16 v[120:121], v19 offset:24576
ds_read_b64_tr_b16 v[122:123], v19 offset:25088
ds_read_b64_tr_b16 v[124:125], v20 offset:24576
ds_read_b64_tr_b16 v[126:127], v20 offset:25088
s_branch L_join
L_slow22:
s_waitcnt vmcnt(0)
v_mov_b32 v1, 7
ds_max_u32 v25, v1
s_mov_b32 s99, 4194304
L_sl22:
ds_read_b32 v29, v25 offset:1024
s_sub_u32 s99, s99, 1
s_cbranch_scc1 L_back22
s_waitcnt lgkmcnt(0)
v_cmp_gt_u32 vcc, 1, v29
s_cbranch_vccz L_back22
s_sleep 1
s_branch L_sl22
L_slow23:
s_waitcnt vmcnt(0)
v_mov_b32 v1, 8
ds_max_u32 v25, v1
s_mov_b32 s99, 4194304
L_sl23:
ds_read_b32 v29, v25 offset:1024
s_sub_u32 s99, s99, 1
s_cbranch_scc1 L_back23
s_waitcnt lgkmcnt(0)
v_cmp_gt_u32 vcc, 2, v29
s_cbranch_vccz L_back23
s_sleep 1
s_branch L_sl23
L_slow24:
s_waitcnt vmcnt(0)
v_mov_b32 v1, 9
ds_max_u32 v25, v1
s_mov_b32 s99, 4194304
L_sl24:
ds_read_b32 v29, v25 offset:1024
s_sub_u32 s99, s99, 1
s_cbranch_scc1 L_back24
s_waitcnt lgkmcnt(0)
v_cmp_gt_u32 vcc, 3, v29
s_cbranch_vccz L_back24
s_sleep 1
s_branch L_sl24
L_slow25:
s_waitcnt vmcnt(0)
v_mov_b32 v1, 10
ds_max_u32 v25, v1
s_mov_b32 s99, 4194304
L_sl25:
ds_read_b32 v29, v25 offset:1024
s_sub_u32 s99, s99, 1
s_cbranch_scc1 L_back25
s_waitcnt lgkmcnt(0)
v_cmp_gt_u32 vcc, 4, v29
s_cbranch_vccz L_back25
s_sleep 1
s_branch L_sl25
L_slow26:
s_waitcnt vmcnt(0)
v_mov_b32 v1, 11
ds_max_u32 v25, v1
s_mov_b32 s99, 4194304
L_sl26:
ds_read_b32 v29, v25 offset:1024
s_sub_u32 s99, s99, 1
s_cbranch_scc1 L_back26
s_waitcnt lgkmcnt(0)
v_cmp_gt_u32 vcc, 5, v29
s_cbranch_vccz L_back26
s_sleep 1
s_branch L_sl26
L_slow27:
s_waitcnt vmcnt(0)
v_mov_b32 v1, 12
ds_max_u32 v25, v1
s_mov_b32 s99, 4194304
L_sl27:
ds_read_b32 v29, v25 offset:1024
s_sub_u32 s99, s99, 1
s_cbranch_scc1 L_back27
s_waitcnt lgkmcnt(0)
v_cmp_gt_u32 vcc, 6, v29
s_cbranch_vccz L_back27
s_sleep 1
s_branch L_sl27
L_slow28:
s_waitcnt vmcnt(0)
v_mov_b32 v1, 13
ds_max_u32 v25, v1
s_mov_b32 s99, 4194304
L_sl28:
ds_read_b32 v29, v25 offset:1024
s_sub_u32 s99, s99, 1
s_cbranch_scc1 L_back28
s_waitcnt lgkmcnt(0)
v_cmp_gt_u32 vcc, 7, v29
s_cbranch_vccz L_back28
s_sleep 1
s_branch L_sl28
L_slow29:
s_waitcnt vmcnt(0)
v_mov_b32 v1, 14
ds_max_u32 v25, v1
s_mov_b32 s99, 4194304
L_sl29:
ds_read_b32 v29, v25 offset:1024
s_sub_u32 s99, s99, 1
s_cbranch_scc1 L_back29
s_waitcnt lgkmcnt(0)
v_cmp_gt_u32 vcc, 8, v29
s_cbranch_vccz L_back29
s_sleep 1
s_branch L_sl29
L_slow30:
s_waitcnt vmcnt(0)
v_mov_b32 v1, 15
ds_max_u32 v25, v1
s_mov_b32 s99, 4194304
L_sl30:
ds_read_b32 v29, v25 offset:1024
s_sub_u32 s99, s99, 1
s_cbranch_scc1 L_back30
s_waitcnt lgkmcnt(0)
v_cmp_gt_u32 vcc, 9, v29
s_cbranch_vccz L_back30
s_sleep 1
s_branch L_sl30
L_slow31:
s_waitcnt vmcnt(0)
v_mov_b32 v1, 16
ds_max_u32 v25, v1
s_mov_b32 s99, 4194304
L_sl31:
ds_read_b32 v29, v25 offset:1024
s_sub_u32 s99, s99, 1
s_cbranch_scc1 L_back31
s_waitcnt lgkmcnt(0)
v_cmp_gt_u32 vcc, 10, v29
s_cbranch_vccz L_back31
s_sleep 1
s_branch L_sl31
L_slow32:
s_waitcnt vmcnt(0)
v_mov_b32 v1, 17
ds_max_u32 v25, v1
s_mov_b32 s99, 4194304
L_sl32:
ds_read_b32 v29, v25 offset:1024
s_sub_u32 s99, s99, 1
s_cbranch_scc1 L_back32
s_waitcnt lgkmcnt(0)
v_cmp_gt_u32 vcc, 11, v29
s_cbranch_vccz L_back32
s_sleep 1
s_branch L_sl32
L_slow33:
s_waitcnt vmcnt(0)
v_mov_b32 v1, 18
ds_max_u32 v25, v1
s_mov_b32 s99, 4194304
L_sl33:
ds_read_b32 v29, v25 offset:1024
s_sub_u32 s99, s99, 1
s_cbranch_scc1 L_back33
s_waitcnt lgkmcnt(0)
v_cmp_gt_u32 vcc, 12, v29
s_cbranch_vccz L_back33
s_sleep 1
s_branch L_sl33
L_slow34:
s_waitcnt vmcnt(0)
v_mov_b32 v1, 19
ds_max_u32 v25, v1
s_mov_b32 s99, 4194304
L_sl34:
ds_read_b32 v29, v25 offset:1024
s_sub_u32 s99, s99, 1
s_cbranch_scc1 L_back34
s_waitcnt lgkmcnt(0)
v_cmp_gt_u32 vcc, 13, v29
s_cbranch_vccz L_back34
s_sleep 1
s_branch L_sl34
L_slow35:
s_waitcnt vmcnt(0)
v_mov_b32 v1, 20
ds_max_u32 v25, v1
s_mov_b32 s99, 4194304
L_sl35:
ds_read_b32 v29, v25 offset:1024
s_sub_u32 s99, s99, 1
s_cbranch_scc1 L_back35
s_waitcnt lgkmcnt(0)
v_cmp_gt_u32 vcc, 14, v29
s_cbranch_vccz L_back35
s_sleep 1
s_branch L_sl35
L_slow36:
s_waitcnt vmcnt(0)
v_mov_b32 v1, 21
ds_max_u32 v25, v1
s_mov_b32 s99, 4194304
L_sl36:
ds_read_b128 v[136:139], v26 offset:1024
s_sub_u32 s99, s99, 1
s_cbranch_scc1 L_back36
s_waitcnt lgkmcnt(0)
v_min_u32 v29, v136, v137
v_min3_u32 v29, v138, v139, v29
v_cmp_gt_u32 vcc, 15, v29
s_cbranch_vccz L_back36
s_sleep 1
s_branch L_sl36
L_slow37:
s_waitcnt vmcnt(0)
v_mov_b32 v1, 22
ds_max_u32 v25, v1
s_mov_b32 s99, 4194304
L_sl37:
ds_read_b128 v[136:139], v26 offset:1024
s_sub_u32 s99, s99, 1
s_cbranch_scc1 L_back37
s_waitcnt lgkmcnt(0)
v_min_u32 v29, v136, v137
v_min3_u32 v29, v138, v139, v29
v_cmp_gt_u32 vcc, 16, v29
s_cbranch_vccz L_back37
s_sleep 1
s_branch L_sl37
L_slow38:
s_waitcnt vmcnt(0)
v_mov_b32 v1, 23
ds_max_u32 v25, v1
s_mov_b32 s99, 4194304
L_sl38:
ds_read_b128 v[136:139], v26 offset:1024
s_sub_u32 s99, s99, 1
s_cbranch_scc1 L_back38
s_waitcnt lgkmcnt(0)
v_min_u32 v29, v136, v137
v_min3_u32 v29, v138, v139, v29
v_cmp_gt_u32 vcc, 17, v29
s_cbranch_vccz L_back38
s_sleep 1
s_branch L_sl38
L_slow39:
s_waitcnt vmcnt(0)
v_mov_b32 v1, 24
ds_max_u32 v25, v1
s_mov_b32 s99, 4194304
L_sl39:
ds_read_b128 v[136:139], v26 offset:1024
s_sub_u32 s99, s99, 1
s_cbranch_scc1 L_back39
s_waitcnt lgkmcnt(0)
v_min_u32 v29, v136, v137
v_min3_u32 v29, v138, v139, v29
v_cmp_gt_u32 vcc, 18, v29
s_cbranch_vccz L_back39
s_sleep 1
s_branch L_sl39
L_slow40:
s_waitcnt vmcnt(0)
v_mov_b32 v1, 24
ds_max_u32 v25, v1
s_mov_b32 s99, 4194304
L_sl40:
ds_read_b128 v[136:139], v26 offset:1024
s_sub_u32 s99, s99, 1
s_cbranch_scc1 L_back40
s_waitcnt lgkmcnt(0)
v_min_u32 v29, v136, v137
v_min3_u32 v29, v138, v139, v29
v_cmp_gt_u32 vcc, 19, v29
s_cbranch_vccz L_back40
s_sleep 1
s_branch L_sl40
L_slow41:
s_waitcnt vmcnt(0)
v_mov_b32 v1, 24
ds_max_u32 v25, v1
s_mov_b32 s99, 4194304
L_sl41:
ds_read_b128 v[136:139], v26 offset:1024
s_sub_u32 s99, s99, 1
s_cbranch_scc1 L_back41
s_waitcnt lgkmcnt(0)
v_min_u32 v29, v136, v137
v_min3_u32 v29, v138, v139, v29
v_cmp_gt_u32 vcc, 20, v29
s_cbranch_vccz L_back41
s_sleep 1
s_branch L_sl41
L_slow42:
s_waitcnt vmcnt(0)
v_mov_b32 v1, 24
ds_max_u32 v25, v1
s_mov_b32 s99, 4194304
L_sl42:
ds_read_b128 v[136:139], v26 offset:1024
s_sub_u32 s99, s99, 1
s_cbranch_scc1 L_back42
s_waitcnt lgkmcnt(0)
v_min_u32 v29, v136, v137
v_min3_u32 v29, v138, v139, v29
v_cmp_gt_u32 vcc, 21, v29
s_cbranch_vccz L_back42
s_sleep 1
s_branch L_sl42
L_cons:
v_lshlrev_b32 v4, 4, v0
v_lshrrev_b32 v1, 4, v0
v_and_b32 v2, 15, v0
v_lshlrev_b32 v1, 11, v1
v_lshl_add_u32 v30, v2, 4, v1
s_lshl_b32 s100, s79, 10
s_lshl_b32 s31, s3, 8
s_add_u32 s100, s100, s31
s_mov_b32 s62, 8192
s_mov_b32 s63, 0x20000
v_mov_b32 v140, 0
v_mov_b32 v141, 0
v_mov_b32 v142, 0
v_mov_b32 v143, 0
s_min_u32 s31, s3, 2
s_lshl_b32 s31, s31, 10
s_add_u32 s31, s31, 146816
v_add_u32 v1, s31, v4
ds_write_b128 v1, v[140:143]
v_mov_b32 v1, 145728
ds_write_b32 v1, v140 offset:16
s_cmp_eq_u32 s30, 0
s_waitcnt lgkmcnt(0)
s_cselect_b32 s60, s4, s14
s_cselect_b32 s61, s5, s15
s_barrier
s_load_dwordx2 s[40:41], s[28:29], 393216
buffer_load_dwordx4 v[32:35], v30, s[60:63], s100 offen offset:0
s_mov_b32 s56, s28
s_mov_b32 s57, s29
s_mov_b32 s58, 2621440
s_mov_b32 s59, 0x20000
s_mov_b32 s64, s24
s_mov_b32 s65, s25
s_mov_b32 s66, 16384
s_mov_b32 s67, 0x20000
s_and_b32 s4, s2, 15
s_lshr_b32 s5, s2, 4
s_bfe_u32 s6, s2, 0x20001
s_lshr_b32 s7, s2, 5
s_lshl_b32 s7, s7, 2
s_or_b32 s6, s6, s7
s_bfe_u32 s7, s2, 0x20003
v_bfe_u32 v1, v0, 4, 1
v_lshlrev_b32 v1, 14, v1
v_and_b32 v2, 15, v0
v_lshl_add_u32 v21, v2, 4, v1
s_lshl_b32 s8, s4, 15
s_lshl_b32 s9, s5, 8
s_add_u32 s8, s8, s9
s_lshl_b32 s9, s3, 12
s_add_u32 s8, s8, s9
s_add_u32 s8, s8, 524288
s_add_u32 s9, s8, 524288
v_lshrrev_b32 v1, 4, v0
v_lshlrev_b32 v1, 14, v1
v_and_b32 v2, 15, v0
v_lshl_add_u32 v23, v2, 4, v1
s_lshl_b32 s11, s30, 17
s_lshl_b32 s12, s79, 16
s_add_u32 s11, s11, s12
s_lshl_b32 s12, s78, 8
s_add_u32 s11, s11, s12
v_bfe_u32 v1, v0, 3, 1
v_lshlrev_b32 v1, 15, v1
v_and_b32 v2, 7, v0
v_lshl_add_u32 v24, v2, 4, v1
s_lshl_b32 s12, s4, 11
s_lshl_b32 s13, s5, 7
s_add_u32 s12, s12, s13
s_add_u32 s12, s12, 262144
s_cmp_eq_u32 s3, 1
s_cselect_b32 s12, s12, 2621440
v_and_b32 v1, 7, v0
v_lshlrev_b32 v1, 1, v1
v_bfe_u32 v2, v0, 3, 1
v_or_b32 v1, v1, v2
v_lshrrev_b32 v2, 4, v0
v_lshlrev_b32 v2, 2, v2
v_xor_b32 v1, v1, v2
v_lshlrev_b32 v1, 4, v1
v_and_b32 v2, 15, v0
v_lshl_add_u32 v1, v2, 8, v1
v_add_u32 v5, s77, v1
v_xor_b32 v6, 16, v5
v_xor_b32 v7, 32, v5
v_xor_b32 v8, 48, v5
v_bfe_u32 v1, v0, 2, 3
v_lshlrev_b32 v1, 1, v1
v_lshrrev_b32 v2, 5, v0
v_or_b32 v1, v1, v2
v_bfe_u32 v2, v0, 1, 1
v_xor_b32 v1, v1, v2
v_lshlrev_b32 v1, 4, v1
v_and_b32 v2, 1, v0
v_lshl_add_u32 v1, v2, 3, v1
v_lshrrev_b32 v2, 2, v0
v_lshl_add_u32 v1, v2, 8, v1
s_lshl_b32 s13, s3, 6
v_xor_b32 v9, s13, v1
v_xor_b32 v10, 32, v9
v_add_u32 v11, 57344, v9
v_add_u32 v12, 57344, v10
v_bfe_u32 v1, v0, 3, 2
v_lshlrev_b32 v1, 5, v1
v_and_b32 v2, 3, v0
v_lshl_add_u32 v1, v2, 3, v1
v_bfe_u32 v2, v0, 2, 2
v_lshl_add_u32 v1, v2, 7, v1
v_lshrrev_b32 v2, 4, v0
v_lshl_add_u32 v1, v2, 10, v1
v_add_u32 v17, s77, v1
v_xor_b32 v18, 32, v17
v_xor_b32 v19, 64, v17
v_xor_b32 v20, 96, v17
s_mov_b32 s14, 0xf0f0f0f0
s_mov_b32 s15, s14
s_mov_b32 s16, 0xff00ff00
s_mov_b32 s17, s16
v_add_u32 v26, 146816, v4
s_lshl_b32 s13, s3, 2
v_add_u32 v25, s13, v26
v_add_u32 v28, 148864, v4
s_lshl_b32 s13, s3, 2
v_add_u32 v27, s13, v28
s_mov_b32 s20, 1040356334
s_waitcnt lgkmcnt(0)
s_add_u32 s19, s40, 0x9e3779b1
s_not_b32 s27, s41
s_xor_b32 s42, s27, 0x6c8e9cf4
s_mul_i32 s26, s19, 0x85ebca6b
s_xor_b32 s26, s26, 0x5bd1e995
s_mov_b32 s18, 0xffffff00
s_bfe_u32 s68, s19, 524288
s_bfe_u32 s69, s19, 524296
s_bfe_u32 s70, s19, 524304
s_bfe_u32 s71, s19, 524312
v_mov_b32 v136, s42
v_mov_b32 v1, 145728
ds_write_b32 v1, v136
v_mov_b32 v31, s18
s_mov_b32 s99, 4194304
L_f43:
ds_read_b32 v29, v25
s_sub_u32 s99, s99, 1
s_cbranch_scc1 L_fo43
s_waitcnt lgkmcnt(0)
v_cmp_gt_u32 vcc, 1, v29
s_cbranch_vccnz L_f43
L_fo43:
ds_read_b64_tr_b16 v[64:65], v17 offset:0
ds_read_b64_tr_b16 v[66:67], v17 offset:512
ds_read_b64_tr_b16 v[68:69], v18 offset:0
ds_read_b64_tr_b16 v[70:71], v18 offset:512
ds_read_b64_tr_b16 v[72:73], v19 offset:0
ds_read_b64_tr_b16 v[74:75], v19 offset:512
ds_read_b64_tr_b16 v[76:77], v20 offset:0
ds_read_b64_tr_b16 v[78:79], v20 offset:512
v_mov_b32 v1, 1
ds_write_b32 v25, v1 offset:1024
s_waitcnt vmcnt(0)
s_lshl_b32 s13, s3, 10
s_add_u32 s13, s13, 135168
v_add_u32 v3, s13, v4
ds_write_b128 v3, v[32:35]
v_and_b32 v1, 3, v0
v_lshrrev_b32 v2, 4, v0
v_lshlrev_b32 v1, 8, v1
v_lshl_add_u32 v1, v2, 4, v1
v_add_u32 v3, s13, v1
ds_read_b128 v[32:35], v3 offset:0
ds_read_b128 v[36:39], v3 offset:64
ds_read_b128 v[40:43], v3 offset:128
ds_read_b128 v[44:47], v3 offset:192
s_waitcnt lgkmcnt(0)
v_mfma_f32_16x16x32_bf16 v[48:51], v[64:67], v[32:35], 0
v_mfma_f32_16x16x32_bf16 v[52:55], v[68:71], v[32:35], 0
v_mfma_f32_16x16x32_bf16 v[56:59], v[72:75], v[32:35], 0
v_mfma_f32_16x16x32_bf16 v[60:63], v[76:79], v[32:35], 0
s_mov_b32 s99, 4194304
L_f44:
ds_read_b32 v29, v25
s_sub_u32 s99, s99, 1
s_cbranch_scc1 L_fo44
s_waitcnt lgkmcnt(0)
v_cmp_gt_u32 vcc, 2, v29
s_cbranch_vccnz L_f44
L_fo44:
ds_read_b64_tr_b16 v[64:65], v17 offset:4096
ds_read_b64_tr_b16 v[66:67], v17 offset:4608
ds_read_b64_tr_b16 v[68:69], v18 offset:4096
ds_read_b64_tr_b16 v[70:71], v18 offset:4608
ds_read_b64_tr_b16 v[72:73], v19 offset:4096
ds_read_b64_tr_b16 v[74:75], v19 offset:4608
ds_read_b64_tr_b16 v[76:77], v20 offset:4096
ds_read_b64_tr_b16 v[78:79], v20 offset:4608
v_mov_b32 v1, 2
ds_write_b32 v25, v1 offset:1024
s_waitcnt lgkmcnt(0)
v_mfma_f32_16x16x32_bf16 v[48:51], v[64:67], v[36:39], v[48:51]
v_mfma_f32_16x16x32_bf16 v[52:55], v[68:71], v[36:39], v[52:55]
v_mfma_f32_16x16x32_bf16 v[56:59], v[72:75], v[36:39], v[56:59]
v_mfma_f32_16x16x32_bf16 v[60:63], v[76:79], v[36:39], v[60:63]
s_mov_b32 s99, 4194304
L_f45:
ds_read_b32 v29, v25
s_sub_u32 s99, s99, 1
s_cbranch_scc1 L_fo45
s_waitcnt lgkmcnt(0)
v_cmp_gt_u32 vcc, 3, v29
s_cbranch_vccnz L_f45
L_fo45:
ds_read_b128 v[160:163], v5 offset:8192
ds_read_b128 v[164:167], v6 offset:8192
ds_read_b128 v[168:171], v7 offset:8192
ds_read_b128 v[172:175], v8 offset:8192
v_mov_b32 v1, 3
ds_write_b32 v25, v1 offset:1024
s_mov_b32 s99, 4194304
L_f46:
ds_read_b32 v29, v25
s_sub_u32 s99, s99, 1
s_cbranch_scc1 L_fo46
s_waitcnt lgkmcnt(0)
v_cmp_gt_u32 vcc, 4, v29
s_cbranch_vccnz L_f46
L_fo46:
ds_read_b64_tr_b16 v[64:65], v17 offset:12288
ds_read_b64_tr_b16 v[66:67], v17 offset:12800
ds_read_b64_tr_b16 v[68:69], v18 offset:12288
ds_read_b64_tr_b16 v[70:71], v18 offset:12800
ds_read_b64_tr_b16 v[72:73], v19 offset:12288
ds_read_b64_tr_b16 v[74:75], v19 offset:12800
ds_read_b64_tr_b16 v[76:77], v20 offset:12288
ds_read_b64_tr_b16 v[78:79], v20 offset:12800
v_mov_b32 v1, 4
ds_write_b32 v25, v1 offset:1024
s_waitcnt lgkmcnt(0)
v_mfma_f32_16x16x32_bf16 v[48:51], v[64:67], v[40:43], v[48:51]
v_mfma_f32_16x16x32_bf16 v[52:55], v[68:71], v[40:43], v[52:55]
v_mfma_f32_16x16x32_bf16 v[56:59], v[72:75], v[40:43], v[56:59]
v_mfma_f32_16x16x32_bf16 v[60:63], v[76:79], v[40:43], v[60:63]
s_mov_b32 s99, 4194304
L_f47:
ds_read_b32 v29, v25
s_sub_u32 s99, s99, 1
s_cbranch_scc1 L_fo47
s_waitcnt lgkmcnt(0)
v_cmp_gt_u32 vcc, 5, v29
s_cbranch_vccnz L_f47
L_fo47:
ds_read_b128 v[176:179], v5 offset:16384
ds_read_b128 v[180:183], v6 offset:16384
ds_read_b128 v[184:187], v7 offset:16384
ds_read_b128 v[188:191], v8 offset:16384
v_mov_b32 v1, 5
ds_write_b32 v25, v1 offset:1024
s_mov_b32 s99, 4194304
L_f48:
ds_read_b32 v29, v25
s_sub_u32 s99, s99, 1
s_cbranch_scc1 L_fo48
s_waitcnt lgkmcnt(0)
v_cmp_gt_u32 vcc, 6, v29
s_cbranch_vccnz L_f48
L_fo48:
ds_read_b64_tr_b16 v[64:65], v17 offset:20480
ds_read_b64_tr_b16 v[66:67], v17 offset:20992
ds_read_b64_tr_b16 v[68:69], v18 offset:20480
ds_read_b64_tr_b16 v[70:71], v18 offset:20992
ds_read_b64_tr_b16 v[72:73], v19 offset:20480
ds_read_b64_tr_b16 v[74:75], v19 offset:20992
ds_read_b64_tr_b16 v[76:77], v20 offset:20480
ds_read_b64_tr_b16 v[78:79], v20 offset:20992
v_mov_b32 v1, 6
ds_write_b32 v25, v1 offset:1024
s_waitcnt lgkmcnt(0)
v_mfma_f32_16x16x32_bf16 v[48:51], v[64:67], v[44:47], v[48:51]
v_mfma_f32_16x16x32_bf16 v[52:55], v[68:71], v[44:47], v[52:55]
v_mfma_f32_16x16x32_bf16 v[56:59], v[72:75], v[44:47], v[56:59]
v_mfma_f32_16x16x32_bf16 v[60:63], v[76:79], v[44:47], v[60:63]
s_lshl_b32 s13, s3, 10
s_add_u32 s13, s13, 135168
v_and_b32 v1, 3, v0
v_lshlrev_b32 v1, 8, v1
v_bfe_u32 v2, v0, 2, 2
v_lshl_add_u32 v1, v2, 6, v1
v_lshrrev_b32 v2, 4, v0
v_lshl_add_u32 v1, v2, 4, v1
v_add_u32 v3, s13, v1
v_add_u32 v2, 135168, v4
v_cndmask_b32 v48, v48, v52, s[14:15]
v_cndmask_b32 v56, v56, v60, s[14:15]
v_cndmask_b32 v49, v49, v53, s[14:15]
v_cndmask_b32 v57, v57, v61, s[14:15]
v_cndmask_b32 v50, v50, v54, s[14:15]
v_cndmask_b32 v58, v58, v62, s[14:15]
v_cndmask_b32 v51, v51, v55, s[14:15]
v_cndmask_b32 v59, v59, v63, s[14:15]
v_cndmask_b32 v64, v48, v56, s[16:17]
v_cndmask_b32 v65, v49, v57, s[16:17]
v_cndmask_b32 v66, v50, v58, s[16:17]
v_cndmask_b32 v67, v51, v59, s[16:17]
ds_write_b128 v3, v[64:67]
v_mov_b32 v1, 1
ds_write_b32 v27, v1
s_cmp_lg_u32 s3, 0
s_cbranch_scc1 L_noqp
s_mov_b32 s99, 4194304
L_b49:
ds_read_b128 v[148:151], v28
ds_read_b128 v[64:67], v2 offset:0
ds_read_b128 v[68:71], v2 offset:1024
ds_read_b128 v[72:75], v2 offset:2048
ds_read_b128 v[76:79], v2 offset:3072
s_sub_u32 s99, s99, 1
s_cbranch_scc1 L_bo49
s_waitcnt lgkmcnt(0)
v_min_u32 v29, v148, v149
v_min3_u32 v29, v150, v151, v29
v_cmp_gt_u32 vcc, 1, v29
s_cbranch_vccnz L_b49
L_bo49:
v_add_f32 v64, v64, v68
v_add_f32 v72, v72, v76
v_add_f32 v65, v65, v69
v_add_f32 v73, v73, v77
v_add_f32 v66, v66, v70
v_add_f32 v74, v74, v78
v_add_f32 v67, v67, v71
v_add_f32 v75, v75, v79
v_add_f32 v64, v64, v72
v_add_f32 v65, v65, v73
v_add_f32 v66, v66, v74
v_add_f32 v67, v67, v75
v_and_or_b32 v64, v64, v31, s68
v_and_or_b32 v65, v65, v31, s69
v_and_or_b32 v66, v66, v31, s70
v_and_or_b32 v67, v67, v31, s71
buffer_store_dwordx4 v[64:67], v23, s[56:59], s11 offen sc1
L_noqp:
s_lshr_b32 s21, s3, 1
s_lshl_b32 s21, s21, 17
s_lshl_b32 s13, s4, 12
s_add_u32 s21, s21, s13
s_and_b32 s13, s3, 1
s_lshl_b32 s13, s13, 11
s_add_u32 s21, s21, s13
s_add_u32 s22, s21, 65536
s_mov_b32 s99, 4194304
L_f50:
ds_read_b32 v29, v25
s_sub_u32 s99, s99, 1
s_cbranch_scc1 L_fo50
s_waitcnt lgkmcnt(0)
v_cmp_gt_u32 vcc, 7, v29
s_cbranch_vccnz L_f50
L_fo50:
ds_read_b128 v[192:195], v5 offset:24576
ds_read_b128 v[196:199], v6 offset:24576
ds_read_b128 v[200:203], v7 offset:24576
ds_read_b128 v[204:207], v8 offset:24576
v_mov_b32 v1, 7
ds_write_b32 v25, v1 offset:1024
s_mov_b32 s99, 4194304
L_f51:
ds_read_b32 v29, v25
s_sub_u32 s99, s99, 1
s_cbranch_scc1 L_fo51
s_waitcnt lgkmcnt(0)
v_cmp_gt_u32 vcc, 8, v29
s_cbranch_vccnz L_f51
L_fo51:
ds_read_b128 v[208:211], v5 offset:0
ds_read_b128 v[212:215], v6 offset:0
ds_read_b128 v[216:219], v7 offset:0
ds_read_b128 v[220:223], v8 offset:0
v_mov_b32 v1, 8
ds_write_b32 v25, v1 offset:1024
s_mov_b32 s99, 4194304
L_f52:
ds_read_b32 v29, v25
s_sub_u32 s99, s99, 1
s_cbranch_scc1 L_fo52
s_waitcnt lgkmcnt(0)
v_cmp_gt_u32 vcc, 9, v29
s_cbranch_vccnz L_f52
L_fo52:
ds_read_b128 v[224:227], v5 offset:4096
ds_read_b128 v[228:231], v6 offset:4096
ds_read_b128 v[232:235], v7 offset:4096
ds_read_b128 v[236:239], v8 offset:4096
v_mov_b32 v1, 9
ds_write_b32 v25, v1 offset:1024
s_mov_b32 s99, 4194304
L_f53:
ds_read_b32 v29, v25
s_sub_u32 s99, s99, 1
s_cbranch_scc1 L_fo53
s_waitcnt lgkmcnt(0)
v_cmp_gt_u32 vcc, 10, v29
s_cbranch_vccnz L_f53
L_fo53:
ds_read_b128 v[240:243], v5 offset:8192
ds_read_b128 v[244:247], v6 offset:8192
ds_read_b128 v[248:251], v7 offset:8192
ds_read_b128 v[252:255], v8 offset:8192
v_mov_b32 v1, 10
ds_write_b32 v25, v1 offset:1024
s_mov_b32 s99, 4194304
L_f54:
ds_read_b32 v29, v25
s_sub_u32 s99, s99, 1
s_cbranch_scc1 L_fo54
s_waitcnt lgkmcnt(0)
v_cmp_gt_u32 vcc, 11, v29
s_cbranch_vccnz L_f54
L_fo54:
buffer_load_dwordx4 v[136:139], v4, s[56:59], s21 offen offset:0 sc1
buffer_load_dwordx4 v[140:143], v4, s[56:59], s21 offen offset:1024 sc1
buffer_load_dwordx4 v[144:147], v4, s[56:59], s22 offen offset:0 sc1
buffer_load_dwordx4 v[148:151], v4, s[56:59], s22 offen offset:1024 sc1
s_lshr_b32 s13, s3, 1
s_mul_i32 s13, s13, 2176
s_and_b32 s23, s3, 1
s_mul_i32 s23, s23, 1088
s_add_u32 s13, s13, s23
s_add_u32 s13, s13, 139264
v_lshrrev_b32 v3, 5, v0
v_mul_u32_u24 v3, 272, v3
v_and_b32 v2, 31, v0
v_lshl_add_u32 v3, v2, 3, v3
v_add_u32 v3, s13, v3
v_and_b32 v2, 7, v0
v_mul_u32_u24 v2, 272, v2
v_lshrrev_b32 v1, 4, v0
v_lshl_add_u32 v2, v1, 6, v2
v_add_u32 v2, 139264, v2
s_mov_b32 s99, 262144
s_waitcnt vmcnt(0)
L_chk55:
v_xor_b32 v136, s68, v136
v_xor_b32 v137, s69, v137
v_xor_b32 v138, s70, v138
v_xor_b32 v139, s71, v139
v_xor_b32 v140, s68, v140
v_xor_b32 v141, s69, v141
v_xor_b32 v142, s70, v142
v_xor_b32 v143, s71, v143
v_xor_b32 v144, s68, v144
v_xor_b32 v145, s69, v145
v_xor_b32 v146, s70, v146
v_xor_b32 v147, s71, v147
v_xor_b32 v148, s68, v148
v_xor_b32 v149, s69, v149
v_xor_b32 v150, s70, v150
v_xor_b32 v151, s71, v151
v_or_b32 v29, v136, v137
v_or3_b32 v29, v138, v139, v29
v_or3_b32 v29, v140, v141, v29
v_or3_b32 v29, v142, v143, v29
v_or3_b32 v29, v144, v145, v29
v_or3_b32 v29, v146, v147, v29
v_or3_b32 v29, v148, v149, v29
v_or3_b32 v29, v150, v151, v29
v_and_b32 v29, 0xff, v29
v_cmp_ne_u32 vcc, 0, v29
s_cbranch_vccz L_ok55
s_sub_u32 s99, s99, 1
s_cbranch_scc1 L_ok55
s_sleep 8
buffer_load_dwordx4 v[136:139], v4, s[56:59], s21 offen offset:0 sc1
buffer_load_dwordx4 v[140:143], v4, s[56:59], s21 offen offset:1024 sc1
buffer_load_dwordx4 v[144:147], v4, s[56:59], s22 offen offset:0 sc1
buffer_load_dwordx4 v[148:151], v4, s[56:59], s22 offen offset:1024 sc1
s_waitcnt vmcnt(0)
s_branch L_chk55
L_ok55:
v_add_f32 v136, v136, v144
v_add_f32 v137, v137, v145
v_add_f32 v138, v138, v146
v_add_f32 v139, v139, v147
v_add_f32 v140, v140, v148
v_add_f32 v141, v141, v149
v_add_f32 v142, v142, v150
v_add_f32 v143, v143, v151
v_cvt_pk_bf16_f32 v144, v136, v137
v_cvt_pk_bf16_f32 v145, v138, v139
v_cvt_pk_bf16_f32 v146, v140, v141
v_cvt_pk_bf16_f32 v147, v142, v143
ds_write_b64 v3, v[144:145]
ds_write_b64 v3, v[146:147] offset:544
v_mov_b32 v1, 2
ds_write_b32 v27, v1
s_mov_b32 s99, 4194304
L_b56:
ds_read_b128 v[148:151], v28
ds_read_b128 v[64:67], v2 offset:0
ds_read_b128 v[68:71], v2 offset:16
ds_read_b128 v[72:75], v2 offset:32
ds_read_b128 v[76:79], v2 offset:48
ds_read_b128 v[80:83], v2 offset:2176
ds_read_b128 v[84:87], v2 offset:2192
ds_read_b128 v[88:91], v2 offset:2208
ds_read_b128 v[92:95], v2 offset:2224
s_sub_u32 s99, s99, 1
s_cbranch_scc1 L_bo56
s_waitcnt lgkmcnt(0)
v_min_u32 v29, v148, v149
v_min3_u32 v29, v150, v151, v29
v_cmp_gt_u32 vcc, 2, v29
s_cbranch_vccnz L_b56
L_bo56:
v_mfma_f32_16x16x32_bf16 v[96:99], v[160:163], v[64:67], 0
v_mfma_f32_16x16x32_bf16 v[96:99], v[164:167], v[68:71], v[96:99]
v_mfma_f32_16x16x32_bf16 v[96:99], v[168:171], v[72:75], v[96:99]
v_mfma_f32_16x16x32_bf16 v[96:99], v[172:175], v[76:79], v[96:99]
v_mfma_f32_16x16x32_bf16 v[100:103], v[176:179], v[64:67], 0
v_mfma_f32_16x16x32_bf16 v[100:103], v[180:183], v[68:71], v[100:103]
v_mfma_f32_16x16x32_bf16 v[100:103], v[184:187], v[72:75], v[100:103]
v_mfma_f32_16x16x32_bf16 v[100:103], v[188:191], v[76:79], v[100:103]
v_mfma_f32_16x16x32_bf16 v[104:107], v[192:195], v[80:83], 0
v_mfma_f32_16x16x32_bf16 v[104:107], v[196:199], v[84:87], v[104:107]
v_mfma_f32_16x16x32_bf16 v[104:107], v[200:203], v[88:91], v[104:107]
v_mfma_f32_16x16x32_bf16 v[104:107], v[204:207], v[92:95], v[104:107]
v_mfma_f32_16x16x32_bf16 v[108:111], v[208:211], v[80:83], 0
v_mfma_f32_16x16x32_bf16 v[108:111], v[212:215], v[84:87], v[108:111]
v_mfma_f32_16x16x32_bf16 v[108:111], v[216:219], v[88:91], v[108:111]
v_mfma_f32_16x16x32_bf16 v[108:111], v[220:223], v[92:95], v[108:111]
v_mfma_f32_16x16x32_bf16 v[112:115], v[224:227], v[80:83], 0
v_mfma_f32_16x16x32_bf16 v[112:115], v[228:231], v[84:87], v[112:115]
v_mfma_f32_16x16x32_bf16 v[112:115], v[232:235], v[88:91], v[112:115]
v_mfma_f32_16x16x32_bf16 v[112:115], v[236:239], v[92:95], v[112:115]
v_mfma_f32_16x16x32_bf16 v[116:119], v[240:243], v[80:83], 0
v_mfma_f32_16x16x32_bf16 v[116:119], v[244:247], v[84:87], v[116:119]
v_mfma_f32_16x16x32_bf16 v[116:119], v[248:251], v[88:91], v[116:119]
v_mfma_f32_16x16x32_bf16 v[116:119], v[252:255], v[92:95], v[116:119]
s_mov_b32 s99, 4194304
L_f57:
ds_read_b32 v29, v25
s_sub_u32 s99, s99, 1
s_cbranch_scc1 L_fo57
s_waitcnt lgkmcnt(0)
v_cmp_gt_u32 vcc, 11, v29
s_cbranch_vccnz L_f57
L_fo57:
ds_read_b128 v[32:35], v5 offset:12288
ds_read_b128 v[36:39], v6 offset:12288
ds_read_b128 v[40:43], v7 offset:12288
ds_read_b128 v[44:47], v8 offset:12288
v_mov_b32 v1, 11
ds_write_b32 v25, v1 offset:1024
s_waitcnt lgkmcnt(0)
v_mfma_f32_16x16x32_bf16 v[120:123], v[32:35], v[80:83], 0
v_mfma_f32_16x16x32_bf16 v[120:123], v[36:39], v[84:87], v[120:123]
v_mfma_f32_16x16x32_bf16 v[120:123], v[40:43], v[88:91], v[120:123]
v_mfma_f32_16x16x32_bf16 v[120:123], v[44:47], v[92:95], v[120:123]
s_mov_b32 s99, 4194304
L_f58:
ds_read_b32 v29, v25
s_sub_u32 s99, s99, 1
s_cbranch_scc1 L_fo58
s_waitcnt lgkmcnt(0)
v_cmp_gt_u32 vcc, 12, v29
s_cbranch_vccnz L_f58
L_fo58:
ds_read_b128 v[48:51], v5 offset:16384
ds_read_b128 v[52:55], v6 offset:16384
ds_read_b128 v[56:59], v7 offset:16384
ds_read_b128 v[60:63], v8 offset:16384
v_mov_b32 v1, 12
ds_write_b32 v25, v1 offset:1024
s_waitcnt lgkmcnt(0)
v_mfma_f32_16x16x32_bf16 v[124:127], v[48:51], v[80:83], 0
v_mfma_f32_16x16x32_bf16 v[124:127], v[52:55], v[84:87], v[124:127]
v_mfma_f32_16x16x32_bf16 v[124:127], v[56:59], v[88:91], v[124:127]
v_mfma_f32_16x16x32_bf16 v[124:127], v[60:63], v[92:95], v[124:127]
s_mov_b32 s99, 4194304
L_f59:
ds_read_b32 v29, v25
s_sub_u32 s99, s99, 1
s_cbranch_scc1 L_fo59
s_waitcnt lgkmcnt(0)
v_cmp_gt_u32 vcc, 13, v29
s_cbranch_vccnz L_f59
L_fo59:
ds_read_b128 v[32:35], v5 offset:20480
ds_read_b128 v[36:39], v6 offset:20480
ds_read_b128 v[40:43], v7 offset:20480
ds_read_b128 v[44:47], v8 offset:20480
v_mov_b32 v1, 13
ds_write_b32 v25, v1 offset:1024
v_max_f32 v136, v96, v97
v_max3_f32 v136, v98, v99, v136
v_max3_f32 v136, v100, v101, v136
v_max3_f32 v136, v102, v103, v136
v_mov_b32 v29, v136
s_nop 1
v_permlane16_swap_b32 v136, v29
s_nop 1
v_max_f32 v136, v136, v29
v_mov_b32 v29, v136
s_nop 1
v_permlane32_swap_b32 v136, v29
s_nop 1
v_max_f32 v136, v136, v29
s_waitcnt lgkmcnt(0)
v_mfma_f32_16x16x32_bf16 v[128:131], v[32:35], v[80:83], 0
v_mfma_f32_16x16x32_bf16 v[128:131], v[36:39], v[84:87], v[128:131]
v_mfma_f32_16x16x32_bf16 v[128:131], v[40:43], v[88:91], v[128:131]
v_mfma_f32_16x16x32_bf16 v[128:131], v[44:47], v[92:95], v[128:131]
s_mov_b32 s99, 4194304
L_f60:
ds_read_b32 v29, v25
s_sub_u32 s99, s99, 1
s_cbranch_scc1 L_fo60
s_waitcnt lgkmcnt(0)
v_cmp_gt_u32 vcc, 14, v29
s_cbranch_vccnz L_f60
L_fo60:
ds_read_b128 v[48:51], v5 offset:24576
ds_read_b128 v[52:55], v6 offset:24576
ds_read_b128 v[56:59], v7 offset:24576
ds_read_b128 v[60:63], v8 offset:24576
v_mov_b32 v1, 14
ds_write_b32 v25, v1 offset:1024
s_waitcnt lgkmcnt(0)
v_mfma_f32_16x16x32_bf16 v[132:135], v[48:51], v[80:83], 0
v_mfma_f32_16x16x32_bf16 v[132:135], v[52:55], v[84:87], v[132:135]
v_mfma_f32_16x16x32_bf16 v[132:135], v[56:59], v[88:91], v[132:135]
v_mfma_f32_16x16x32_bf16 v[132:135], v[60:63], v[92:95], v[132:135]
s_lshl_b32 s13, s3, 8
s_add_u32 s13, s13, 143616
v_and_b32 v2, 15, v0
v_lshlrev_b32 v2, 4, v2
v_add_u32 v158, s13, v2
v_add_u32 v2, 143616, v2
s_lshr_b32 s13, s3, 1
s_lshl_b32 s13, s13, 10
s_and_b32 s23, s3, 1
s_lshl_b32 s23, s23, 3
s_add_u32 s13, s13, s23
v_add_u32 v155, 114688, v4
v_add_u32 v154, s13, v155
v_max_f32 v137, v104, v105
v_max3_f32 v137, v106, v107, v137
v_max3_f32 v137, v108, v109, v137
v_max3_f32 v137, v110, v111, v137
v_max3_f32 v137, v112, v113, v137
v_max3_f32 v137, v114, v115, v137
v_max3_f32 v137, v116, v117, v137
v_max3_f32 v137, v118, v119, v137
v_max3_f32 v137, v120, v121, v137
v_max3_f32 v137, v122, v123, v137
v_max3_f32 v137, v124, v125, v137
v_max3_f32 v137, v126, v127, v137
v_max3_f32 v137, v128, v129, v137
v_max3_f32 v137, v130, v131, v137
v_max3_f32 v137, v132, v133, v137
v_max3_f32 v137, v134, v135, v137
v_mov_b32 v29, v137
s_nop 1
v_permlane16_swap_b32 v137, v29
s_nop 1
v_max_f32 v137, v137, v29
v_mov_b32 v29, v137
s_nop 1
v_permlane32_swap_b32 v137, v29
s_nop 1
v_max_f32 v137, v137, v29
ds_write_b64 v158, v[136:137]
v_mov_b32 v1, 3
ds_write_b32 v27, v1
s_mov_b32 s99, 4194304
L_b61:
ds_read_b128 v[148:151], v28
ds_read_b64 v[160:161], v2 offset:0
ds_read_b64 v[162:163], v2 offset:256
ds_read_b64 v[164:165], v2 offset:512
ds_read_b64 v[166:167], v2 offset:768
s_sub_u32 s99, s99, 1
s_cbranch_scc1 L_bo61
s_waitcnt lgkmcnt(0)
v_min_u32 v29, v148, v149
v_min3_u32 v29, v150, v151, v29
v_cmp_gt_u32 vcc, 3, v29
s_cbranch_vccnz L_b61
L_bo61:
v_max_f32 v136, v160, v162
v_max3_f32 v136, v164, v166, v136
v_and_b32 v136, s18, v136
v_mul_f32 v29, s20, v136
v_fma_f32 v96, v96, s20, -v29
v_fma_f32 v97, v97, s20, -v29
v_fma_f32 v98, v98, s20, -v29
v_fma_f32 v99, v99, s20, -v29
v_fma_f32 v100, v100, s20, -v29
v_fma_f32 v101, v101, s20, -v29
v_fma_f32 v102, v102, s20, -v29
v_fma_f32 v103, v103, s20, -v29
v_exp_f32 v96, v96
v_exp_f32 v97, v97
v_exp_f32 v98, v98
v_exp_f32 v99, v99
v_exp_f32 v100, v100
v_exp_f32 v101, v101
v_exp_f32 v102, v102
v_exp_f32 v103, v103
v_max_f32 v137, v161, v163
v_max3_f32 v137, v165, v167, v137
v_and_b32 v137, s18, v137
v_mul_f32 v29, s20, v137
v_fma_f32 v104, v104, s20, -v29
v_fma_f32 v105, v105, s20, -v29
v_fma_f32 v106, v106, s20, -v29
v_fma_f32 v107, v107, s20, -v29
v_fma_f32 v108, v108, s20, -v29
v_fma_f32 v109, v109, s20, -v29
v_fma_f32 v110, v110, s20, -v29
v_fma_f32 v111, v111, s20, -v29
v_fma_f32 v112, v112, s20, -v29
v_fma_f32 v113, v113, s20, -v29
v_fma_f32 v114, v114, s20, -v29
v_fma_f32 v115, v115, s20, -v29
v_fma_f32 v116, v116, s20, -v29
v_fma_f32 v117, v117, s20, -v29
v_fma_f32 v118, v118, s20, -v29
v_fma_f32 v119, v119, s20, -v29
v_fma_f32 v120, v120, s20, -v29
v_fma_f32 v121, v121, s20, -v29
v_fma_f32 v122, v122, s20, -v29
v_fma_f32 v123, v123, s20, -v29
v_fma_f32 v124, v124, s20, -v29
v_fma_f32 v125, v125, s20, -v29
v_fma_f32 v126, v126, s20, -v29
v_fma_f32 v127, v127, s20, -v29
v_fma_f32 v128, v128, s20, -v29
v_fma_f32 v129, v129, s20, -v29
v_fma_f32 v130, v130, s20, -v29
v_fma_f32 v131, v131, s20, -v29
v_fma_f32 v132, v132, s20, -v29
v_fma_f32 v133, v133, s20, -v29
v_fma_f32 v134, v134, s20, -v29
v_fma_f32 v135, v135, s20, -v29
v_exp_f32 v104, v104
v_exp_f32 v105, v105
v_exp_f32 v106, v106
v_exp_f32 v107, v107
v_exp_f32 v108, v108
v_exp_f32 v109, v109
v_exp_f32 v110, v110
v_exp_f32 v111, v111
v_exp_f32 v112, v112
v_exp_f32 v113, v113
v_exp_f32 v114, v114
v_exp_f32 v115, v115
v_exp_f32 v116, v116
v_exp_f32 v117, v117
v_exp_f32 v118, v118
v_exp_f32 v119, v119
v_exp_f32 v120, v120
v_exp_f32 v121, v121
v_exp_f32 v122, v122
v_exp_f32 v123, v123
v_exp_f32 v124, v124
v_exp_f32 v125, v125
v_exp_f32 v126, v126
v_exp_f32 v127, v127
v_exp_f32 v128, v128
v_exp_f32 v129, v129
v_exp_f32 v130, v130
v_exp_f32 v131, v131
v_exp_f32 v132, v132
v_exp_f32 v133, v133
v_exp_f32 v134, v134
v_exp_f32 v135, v135
v_cvt_pk_bf16_f32 v32, v96, v97
v_cvt_pk_bf16_f32 v33, v98, v99
ds_write_b64 v154, v[32:33] offset:0
v_cvt_pk_bf16_f32 v34, v100, v101
v_cvt_pk_bf16_f32 v35, v102, v103
ds_write_b64 v154, v[34:35] offset:2048
v_cvt_pk_bf16_f32 v36, v104, v105
v_cvt_pk_bf16_f32 v37, v106, v107
ds_write_b64 v154, v[36:37] offset:4096
v_cvt_pk_bf16_f32 v38, v108, v109
v_cvt_pk_bf16_f32 v39, v110, v111
ds_write_b64 v154, v[38:39] offset:6144
v_cvt_pk_bf16_f32 v40, v112, v113
v_cvt_pk_bf16_f32 v41, v114, v115
ds_write_b64 v154, v[40:41] offset:8192
v_cvt_pk_bf16_f32 v42, v116, v117
v_cvt_pk_bf16_f32 v43, v118, v119
ds_write_b64 v154, v[42:43] offset:10240
v_cvt_pk_bf16_f32 v44, v120, v121
v_cvt_pk_bf16_f32 v45, v122, v123
ds_write_b64 v154, v[44:45] offset:12288
v_cvt_pk_bf16_f32 v46, v124, v125
v_cvt_pk_bf16_f32 v47, v126, v127
ds_write_b64 v154, v[46:47] offset:14336
v_cvt_pk_bf16_f32 v48, v128, v129
v_cvt_pk_bf16_f32 v49, v130, v131
ds_write_b64 v154, v[48:49] offset:16384
v_cvt_pk_bf16_f32 v50, v132, v133
v_cvt_pk_bf16_f32 v51, v134, v135
ds_write_b64 v154, v[50:51] offset:18432
v_add_f32 v138, v96, v97
v_add_f32 v3, v98, v99
v_add_f32 v138, v138, v100
v_add_f32 v3, v3, v101
v_add_f32 v138, v138, v102
v_add_f32 v3, v3, v103
v_add_f32 v138, v138, v3
v_mov_b32 v29, v138
s_nop 1
v_permlane16_swap_b32 v138, v29
s_nop 1
v_add_f32 v138, v138, v29
v_mov_b32 v29, v138
s_nop 1
v_permlane32_swap_b32 v138, v29
s_nop 1
v_add_f32 v138, v138, v29
v_add_f32 v139, v104, v105
v_add_f32 v3, v106, v107
v_add_f32 v139, v139, v108
v_add_f32 v3, v3, v109
v_add_f32 v139, v139, v110
v_add_f32 v3, v3, v111
v_add_f32 v139, v139, v112
v_add_f32 v3, v3, v113
v_add_f32 v139, v139, v114
v_add_f32 v3, v3, v115
v_add_f32 v139, v139, v116
v_add_f32 v3, v3, v117
v_add_f32 v139, v139, v118
v_add_f32 v3, v3, v119
v_add_f32 v139, v139, v120
v_add_f32 v3, v3, v121
v_add_f32 v139, v139, v122
v_add_f32 v3, v3, v123
v_add_f32 v139, v139, v124
v_add_f32 v3, v3, v125
v_add_f32 v139, v139, v126
v_add_f32 v3, v3, v127
v_add_f32 v139, v139, v128
v_add_f32 v3, v3, v129
v_add_f32 v139, v139, v130
v_add_f32 v3, v3, v131
v_add_f32 v139, v139, v132
v_add_f32 v3, v3, v133
v_add_f32 v139, v139, v134
v_add_f32 v3, v3, v135
v_add_f32 v139, v139, v3
v_mov_b32 v29, v139
s_nop 1
v_permlane16_swap_b32 v139, v29
s_nop 1
v_add_f32 v139, v139, v29
v_mov_b32 v29, v139
s_nop 1
v_permlane32_swap_b32 v139, v29
s_nop 1
v_add_f32 v139, v139, v29
ds_write_b64 v158, v[138:139] offset:8
v_mov_b32 v1, 4
ds_write_b32 v27, v1
s_mov_b32 s99, 4194304
L_b62:
ds_read_b128 v[148:151], v28
ds_read_b64 v[160:161], v2 offset:8
ds_read_b64 v[162:163], v2 offset:264
ds_read_b64 v[164:165], v2 offset:520
ds_read_b64 v[166:167], v2 offset:776
s_sub_u32 s99, s99, 1
s_cbranch_scc1 L_bo62
s_waitcnt lgkmcnt(0)
v_min_u32 v29, v148, v149
v_min3_u32 v29, v150, v151, v29
v_cmp_gt_u32 vcc, 4, v29
s_cbranch_vccnz L_b62
L_bo62:
v_add_f32 v160, v160, v162
v_add_f32 v164, v164, v166
v_add_f32 v138, v160, v164
v_add_f32 v161, v161, v163
v_add_f32 v165, v165, v167
v_add_f32 v139, v161, v165
v_cndmask_b32 v140, v136, v137, s[16:17]
v_cndmask_b32 v141, v138, v139, s[16:17]
v_mov_b32 v142, s19
v_mov_b32 v143, s26
v_or_b32 v140, s68, v140
v_and_or_b32 v141, v141, v31, s69
s_mov_b32 s101, s30
s_lshl_b32 s23, s3, 5
s_add_u32 s23, s23, s6
s_lshl_b32 s13, s101, 7
s_add_u32 s23, s23, s13
s_lshr_b32 s24, s23, 3
s_lshl_b32 s24, s24, 11
s_and_b32 s13, s6, 4
s_lshl_b32 s13, s13, 4
s_add_u32 s24, s24, s13
s_add_u32 s24, s24, 262144
s_lshl_b32 s23, s23, 12
s_add_u32 s23, s23, 524288
s_mov_b32 s25, 0xffff0000
s_mov_b32 s72, 0x8000
v_and_b32 v1, 15, v0
v_lshrrev_b32 v2, 4, v0
v_lshlrev_b32 v3, 7, v1
v_lshl_add_u32 v156, v2, 4, v3
v_lshlrev_b32 v3, 8, v1
v_lshl_add_u32 v159, v2, 4, v3
s_lshl_b32 s13, s3, 8
s_add_u32 s13, s13, 145792
v_lshlrev_b32 v3, 4, v1
v_lshl_add_u32 v3, v2, 2, v3
v_add_u32 v13, s13, v3
v_lshlrev_b32 v3, 4, v2
v_add_u32 v14, s13, v3
s_mul_i32 s13, s3, 272
s_add_u32 s13, s13, 144640
v_lshlrev_b32 v1, 3, v1
v_and_b32 v3, 1, v2
v_lshl_add_u32 v1, v3, 2, v1
v_lshrrev_b32 v3, 1, v2
v_lshl_add_u32 v1, v3, 7, v1
v_add_u32 v157, s13, v1
v_and_b32 v1, 7, v0
v_lshlrev_b32 v1, 2, v1
v_lshrrev_b32 v1, v1, s42
v_lshlrev_b32 v2, 2, v2
v_lshrrev_b32 v2, v2, s42
v_bfe_u32 v240, v1, 0, 1
v_bfe_u32 v244, v2, 0, 1
v_bfe_u32 v241, v1, 1, 1
v_bfe_u32 v245, v2, 1, 1
v_bfe_u32 v242, v1, 2, 1
v_bfe_u32 v246, v2, 2, 1
v_bfe_u32 v243, v1, 3, 1
v_bfe_u32 v247, v2, 3, 1
s_lshl_b32 s21, s2, 12
s_add_u32 s21, s21, 1572864
s_lshr_b32 s22, s2, 2
s_lshl_b32 s22, s22, 7
s_and_b32 s13, s2, 3
s_lshl_b32 s13, s13, 4
s_add_u32 s22, s22, s13
v_bfe_u32 v1, v0, 3, 2
v_lshlrev_b32 v1, 12, v1
v_lshrrev_b32 v2, 5, v0
v_lshl_add_u32 v15, v2, 6, v1
ds_read_b128 v[32:35], v155 offset:0
ds_read_b128 v[36:39], v155 offset:1024
s_mov_b32 s99, 4194304
L_f63:
ds_read_b128 v[148:151], v26
s_sub_u32 s99, s99, 1
s_cbranch_scc1 L_fo63
s_waitcnt lgkmcnt(0)
v_min_u32 v29, v148, v149
v_min3_u32 v29, v150, v151, v29
v_cmp_gt_u32 vcc, 15, v29
s_cbranch_vccnz L_f63
L_fo63:
ds_read_b64_tr_b16 v[160:161], v9 offset:0
ds_read_b64_tr_b16 v[162:163], v9 offset:28672
ds_read_b64_tr_b16 v[164:165], v10 offset:0
ds_read_b64_tr_b16 v[166:167], v10 offset:28672
ds_read_b64_tr_b16 v[168:169], v11 offset:0
ds_read_b64_tr_b16 v[170:171], v11 offset:28672
ds_read_b64_tr_b16 v[172:173], v12 offset:0
ds_read_b64_tr_b16 v[174:175], v12 offset:28672
v_mov_b32 v1, 15
ds_write_b32 v25, v1 offset:1024
s_waitcnt lgkmcnt(0)
v_mfma_f32_16x16x32_bf16 v[192:195], v[32:35], v[160:163], 0
v_mfma_f32_16x16x32_bf16 v[196:199], v[32:35], v[164:167], 0
v_mfma_f32_16x16x32_bf16 v[192:195], v[36:39], v[168:171], v[192:195]
v_mfma_f32_16x16x32_bf16 v[196:199], v[36:39], v[172:175], v[196:199]
ds_read_b128 v[40:43], v155 offset:2048
ds_read_b128 v[44:47], v155 offset:3072
s_mov_b32 s99, 4194304
L_f64:
ds_read_b128 v[148:151], v26
s_sub_u32 s99, s99, 1
s_cbranch_scc1 L_fo64
s_waitcnt lgkmcnt(0)
v_min_u32 v29, v148, v149
v_min3_u32 v29, v150, v151, v29
v_cmp_gt_u32 vcc, 16, v29
s_cbranch_vccnz L_f64
L_fo64:
ds_read_b64_tr_b16 v[176:177], v9 offset:4096
ds_read_b64_tr_b16 v[178:179], v9 offset:32768
ds_read_b64_tr_b16 v[180:181], v10 offset:4096
ds_read_b64_tr_b16 v[182:183], v10 offset:32768
ds_read_b64_tr_b16 v[184:185], v11 offset:4096
ds_read_b64_tr_b16 v[186:187], v11 offset:32768
ds_read_b64_tr_b16 v[188:189], v12 offset:4096
ds_read_b64_tr_b16 v[190:191], v12 offset:32768
v_mov_b32 v1, 16
ds_write_b32 v25, v1 offset:1024
s_waitcnt lgkmcnt(0)
v_mfma_f32_16x16x32_bf16 v[192:195], v[40:43], v[176:179], v[192:195]
v_mfma_f32_16x16x32_bf16 v[196:199], v[40:43], v[180:183], v[196:199]
v_mfma_f32_16x16x32_bf16 v[192:195], v[44:47], v[184:187], v[192:195]
v_mfma_f32_16x16x32_bf16 v[196:199], v[44:47], v[188:191], v[196:199]
ds_read_b128 v[32:35], v155 offset:4096
ds_read_b128 v[36:39], v155 offset:5120
s_mov_b32 s99, 4194304
L_f65:
ds_read_b128 v[148:151], v26
s_sub_u32 s99, s99, 1
s_cbranch_scc1 L_fo65
s_waitcnt lgkmcnt(0)
v_min_u32 v29, v148, v149
v_min3_u32 v29, v150, v151, v29
v_cmp_gt_u32 vcc, 17, v29
s_cbranch_vccnz L_f65
L_fo65:
ds_read_b64_tr_b16 v[160:161], v9 offset:8192
ds_read_b64_tr_b16 v[162:163], v9 offset:36864
ds_read_b64_tr_b16 v[164:165], v10 offset:8192
ds_read_b64_tr_b16 v[166:167], v10 offset:36864
ds_read_b64_tr_b16 v[168:169], v11 offset:8192
ds_read_b64_tr_b16 v[170:171], v11 offset:36864
ds_read_b64_tr_b16 v[172:173], v12 offset:8192
ds_read_b64_tr_b16 v[174:175], v12 offset:36864
v_mov_b32 v1, 17
ds_write_b32 v25, v1 offset:1024
s_waitcnt lgkmcnt(0)
v_mfma_f32_16x16x32_bf16 v[200:203], v[32:35], v[160:163], 0
v_mfma_f32_16x16x32_bf16 v[204:207], v[32:35], v[164:167], 0
v_mfma_f32_16x16x32_bf16 v[200:203], v[36:39], v[168:171], v[200:203]
v_mfma_f32_16x16x32_bf16 v[204:207], v[36:39], v[172:175], v[204:207]
ds_read_b128 v[40:43], v155 offset:6144
ds_read_b128 v[44:47], v155 offset:7168
s_mov_b32 s99, 4194304
L_f66:
ds_read_b128 v[148:151], v26
s_sub_u32 s99, s99, 1
s_cbranch_scc1 L_fo66
s_waitcnt lgkmcnt(0)
v_min_u32 v29, v148, v149
v_min3_u32 v29, v150, v151, v29
v_cmp_gt_u32 vcc, 18, v29
s_cbranch_vccnz L_f66
L_fo66:
ds_read_b64_tr_b16 v[176:177], v9 offset:12288
ds_read_b64_tr_b16 v[178:179], v9 offset:40960
ds_read_b64_tr_b16 v[180:181], v10 offset:12288
ds_read_b64_tr_b16 v[182:183], v10 offset:40960
ds_read_b64_tr_b16 v[184:185], v11 offset:12288
ds_read_b64_tr_b16 v[186:187], v11 offset:40960
ds_read_b64_tr_b16 v[188:189], v12 offset:12288
ds_read_b64_tr_b16 v[190:191], v12 offset:40960
v_mov_b32 v1, 18
ds_write_b32 v25, v1 offset:1024
s_waitcnt lgkmcnt(0)
v_mfma_f32_16x16x32_bf16 v[200:203], v[40:43], v[176:179], v[200:203]
v_mfma_f32_16x16x32_bf16 v[204:207], v[40:43], v[180:183], v[204:207]
v_mfma_f32_16x16x32_bf16 v[200:203], v[44:47], v[184:187], v[200:203]
v_mfma_f32_16x16x32_bf16 v[204:207], v[44:47], v[188:191], v[204:207]
ds_read_b128 v[32:35], v155 offset:8192
ds_read_b128 v[36:39], v155 offset:9216
s_mov_b32 s99, 4194304
L_f67:
ds_read_b128 v[148:151], v26
s_sub_u32 s99, s99, 1
s_cbranch_scc1 L_fo67
s_waitcnt lgkmcnt(0)
v_min_u32 v29, v148, v149
v_min3_u32 v29, v150, v151, v29
v_cmp_gt_u32 vcc, 19, v29
s_cbranch_vccnz L_f67
L_fo67:
ds_read_b64_tr_b16 v[160:161], v9 offset:16384
ds_read_b64_tr_b16 v[162:163], v9 offset:45056
ds_read_b64_tr_b16 v[164:165], v10 offset:16384
ds_read_b64_tr_b16 v[166:167], v10 offset:45056
ds_read_b64_tr_b16 v[168:169], v11 offset:16384
ds_read_b64_tr_b16 v[170:171], v11 offset:45056
ds_read_b64_tr_b16 v[172:173], v12 offset:16384
ds_read_b64_tr_b16 v[174:175], v12 offset:45056
v_mov_b32 v1, 19
ds_write_b32 v25, v1 offset:1024
s_waitcnt lgkmcnt(0)
v_mfma_f32_16x16x32_bf16 v[200:203], v[32:35], v[160:163], v[200:203]
v_mfma_f32_16x16x32_bf16 v[204:207], v[32:35], v[164:167], v[204:207]
v_mfma_f32_16x16x32_bf16 v[200:203], v[36:39], v[168:171], v[200:203]
v_mfma_f32_16x16x32_bf16 v[204:207], v[36:39], v[172:175], v[204:207]
ds_read_b128 v[40:43], v155 offset:10240
ds_read_b128 v[44:47], v155 offset:11264
s_mov_b32 s99, 4194304
L_f68:
ds_read_b128 v[148:151], v26
s_sub_u32 s99, s99, 1
s_cbranch_scc1 L_fo68
s_waitcnt lgkmcnt(0)
v_min_u32 v29, v148, v149
v_min3_u32 v29, v150, v151, v29
v_cmp_gt_u32 vcc, 20, v29
s_cbranch_vccnz L_f68
L_fo68:
ds_read_b64_tr_b16 v[176:177], v9 offset:20480
ds_read_b64_tr_b16 v[178:179], v9 offset:49152
ds_read_b64_tr_b16 v[180:181], v10 offset:20480
ds_read_b64_tr_b16 v[182:183], v10 offset:49152
ds_read_b64_tr_b16 v[184:185], v11 offset:20480
ds_read_b64_tr_b16 v[186:187], v11 offset:49152
ds_read_b64_tr_b16 v[188:189], v12 offset:20480
ds_read_b64_tr_b16 v[190:191], v12 offset:49152
v_mov_b32 v1, 20
ds_write_b32 v25, v1 offset:1024
s_waitcnt lgkmcnt(0)
v_mfma_f32_16x16x32_bf16 v[200:203], v[40:43], v[176:179], v[200:203]
v_mfma_f32_16x16x32_bf16 v[204:207], v[40:43], v[180:183], v[204:207]
v_mfma_f32_16x16x32_bf16 v[200:203], v[44:47], v[184:187], v[200:203]
v_mfma_f32_16x16x32_bf16 v[204:207], v[44:47], v[188:191], v[204:207]
ds_read_b128 v[32:35], v155 offset:12288
ds_read_b128 v[36:39], v155 offset:13312
s_mov_b32 s99, 4194304
L_f69:
ds_read_b128 v[148:151], v26
s_sub_u32 s99, s99, 1
s_cbranch_scc1 L_fo69
s_waitcnt lgkmcnt(0)
v_min_u32 v29, v148, v149
v_min3_u32 v29, v150, v151, v29
v_cmp_gt_u32 vcc, 21, v29
s_cbranch_vccnz L_f69
L_fo69:
ds_read_b64_tr_b16 v[160:161], v9 offset:24576
ds_read_b64_tr_b16 v[162:163], v9 offset:53248
ds_read_b64_tr_b16 v[164:165], v10 offset:24576
ds_read_b64_tr_b16 v[166:167], v10 offset:53248
ds_read_b64_tr_b16 v[168:169], v11 offset:24576
ds_read_b64_tr_b16 v[170:171], v11 offset:53248
ds_read_b64_tr_b16 v[172:173], v12 offset:24576
ds_read_b64_tr_b16 v[174:175], v12 offset:53248
v_mov_b32 v1, 21
ds_write_b32 v25, v1 offset:1024
s_waitcnt lgkmcnt(0)
v_mfma_f32_16x16x32_bf16 v[200:203], v[32:35], v[160:163], v[200:203]
v_mfma_f32_16x16x32_bf16 v[204:207], v[32:35], v[164:167], v[204:207]
v_mfma_f32_16x16x32_bf16 v[200:203], v[36:39], v[168:171], v[200:203]
v_mfma_f32_16x16x32_bf16 v[204:207], v[36:39], v[172:175], v[204:207]
ds_read_b128 v[40:43], v155 offset:14336
ds_read_b128 v[44:47], v155 offset:15360
s_mov_b32 s99, 4194304
L_f70:
ds_read_b128 v[148:151], v26
s_sub_u32 s99, s99, 1
s_cbranch_scc1 L_fo70
s_waitcnt lgkmcnt(0)
v_min_u32 v29, v148, v149
v_min3_u32 v29, v150, v151, v29
v_cmp_gt_u32 vcc, 22, v29
s_cbranch_vccnz L_f70
L_fo70:
ds_read_b64_tr_b16 v[176:177], v9 offset:0
ds_read_b64_tr_b16 v[178:179], v9 offset:28672
ds_read_b64_tr_b16 v[180:181], v10 offset:0
ds_read_b64_tr_b16 v[182:183], v10 offset:28672
ds_read_b64_tr_b16 v[184:185], v11 offset:0
ds_read_b64_tr_b16 v[186:187], v11 offset:28672
ds_read_b64_tr_b16 v[188:189], v12 offset:0
ds_read_b64_tr_b16 v[190:191], v12 offset:28672
s_waitcnt lgkmcnt(0)
v_mfma_f32_16x16x32_bf16 v[200:203], v[40:43], v[176:179], v[200:203]
v_mfma_f32_16x16x32_bf16 v[204:207], v[40:43], v[180:183], v[204:207]
v_mfma_f32_16x16x32_bf16 v[200:203], v[44:47], v[184:187], v[200:203]
v_mfma_f32_16x16x32_bf16 v[204:207], v[44:47], v[188:191], v[204:207]
ds_read_b128 v[32:35], v155 offset:16384
ds_read_b128 v[36:39], v155 offset:17408
s_mov_b32 s99, 4194304
L_f71:
ds_read_b128 v[148:151], v26
s_sub_u32 s99, s99, 1
s_cbranch_scc1 L_fo71
s_waitcnt lgkmcnt(0)
v_min_u32 v29, v148, v149
v_min3_u32 v29, v150, v151, v29
v_cmp_gt_u32 vcc, 23, v29
s_cbranch_vccnz L_f71
L_fo71:
ds_read_b64_tr_b16 v[160:161], v9 offset:4096
ds_read_b64_tr_b16 v[162:163], v9 offset:32768
ds_read_b64_tr_b16 v[164:165], v10 offset:4096
ds_read_b64_tr_b16 v[166:167], v10 offset:32768
ds_read_b64_tr_b16 v[168:169], v11 offset:4096
ds_read_b64_tr_b16 v[170:171], v11 offset:32768
ds_read_b64_tr_b16 v[172:173], v12 offset:4096
ds_read_b64_tr_b16 v[174:175], v12 offset:32768
s_mov_b64 exec, 0xffff
buffer_store_dwordx4 v[140:143], v24, s[56:59], s12 offen sc1
s_mov_b64 exec, -1
v_cvt_pk_bf16_f32 v192, v192, v193
v_cvt_pk_bf16_f32 v193, v194, v195
v_cvt_pk_bf16_f32 v194, v196, v197
v_cvt_pk_bf16_f32 v195, v198, v199
v_and_or_b32 v192, v192, -2, v240
v_and_or_b32 v193, v193, -2, v241
v_and_or_b32 v194, v194, -2, v242
v_and_or_b32 v195, v195, -2, v243
s_mov_b32 exec_hi, 0
buffer_store_dwordx4 v[192:195], v21, s[56:59], s8 offen sc1
s_mov_b32 exec_hi, -1
s_waitcnt lgkmcnt(0)
v_mfma_f32_16x16x32_bf16 v[200:203], v[32:35], v[160:163], v[200:203]
v_mfma_f32_16x16x32_bf16 v[204:207], v[32:35], v[164:167], v[204:207]
v_mfma_f32_16x16x32_bf16 v[200:203], v[36:39], v[168:171], v[200:203]
v_mfma_f32_16x16x32_bf16 v[204:207], v[36:39], v[172:175], v[204:207]
ds_read_b128 v[40:43], v155 offset:18432
ds_read_b128 v[44:47], v155 offset:19456
s_mov_b32 s99, 4194304
L_f72:
ds_read_b128 v[148:151], v26
s_sub_u32 s99, s99, 1
s_cbranch_scc1 L_fo72
s_waitcnt lgkmcnt(0)
v_min_u32 v29, v148, v149
v_min3_u32 v29, v150, v151, v29
v_cmp_gt_u32 vcc, 24, v29
s_cbranch_vccnz L_f72
L_fo72:
ds_read_b64_tr_b16 v[176:177], v9 offset:8192
ds_read_b64_tr_b16 v[178:179], v9 offset:36864
ds_read_b64_tr_b16 v[180:181], v10 offset:8192
ds_read_b64_tr_b16 v[182:183], v10 offset:36864
ds_read_b64_tr_b16 v[184:185], v11 offset:8192
ds_read_b64_tr_b16 v[186:187], v11 offset:36864
ds_read_b64_tr_b16 v[188:189], v12 offset:8192
ds_read_b64_tr_b16 v[190:191], v12 offset:36864
s_waitcnt lgkmcnt(6)
v_mfma_f32_16x16x32_bf16 v[200:203], v[40:43], v[176:179], v[200:203]
s_waitcnt lgkmcnt(4)
v_mfma_f32_16x16x32_bf16 v[204:207], v[40:43], v[180:183], v[204:207]
s_waitcnt lgkmcnt(2)
v_mfma_f32_16x16x32_bf16 v[200:203], v[44:47], v[184:187], v[200:203]
s_waitcnt lgkmcnt(0)
v_mfma_f32_16x16x32_bf16 v[204:207], v[44:47], v[188:191], v[204:207]
s_nop 7
v_cvt_pk_bf16_f32 v200, v200, v201
v_cvt_pk_bf16_f32 v201, v202, v203
v_cvt_pk_bf16_f32 v202, v204, v205
v_cvt_pk_bf16_f32 v203, v206, v207
v_and_or_b32 v200, v200, -2, v240
v_and_or_b32 v201, v201, -2, v241
v_and_or_b32 v202, v202, -2, v242
v_and_or_b32 v203, v203, -2, v243
s_mov_b32 exec_hi, 0
buffer_store_dwordx4 v[200:203], v21, s[56:59], s9 offen sc1
s_mov_b32 exec_hi, -1
s_mov_b32 s76, 262144
s_mov_b32 s99, 4194304
L_f73:
ds_read_b32 v29, v25
s_sub_u32 s99, s99, 1
s_cbranch_scc1 L_fo73
s_waitcnt lgkmcnt(0)
v_cmp_gt_u32 vcc, 27, v29
s_cbranch_vccnz L_f73
L_fo73:
buffer_load_dwordx4 v[144:147], v156, s[56:59], s24 offen sc1
buffer_load_dwordx4 v[96:99], v4, s[56:59], s23 offen offset:0 sc1
buffer_load_dwordx4 v[100:103], v4, s[56:59], s23 offen offset:1024 sc1
buffer_load_dwordx4 v[104:107], v4, s[56:59], s23 offen offset:2048 sc1
buffer_load_dwordx4 v[108:111], v4, s[56:59], s23 offen offset:3072 sc1
s_waitcnt vmcnt(4)
v_xor_b32 v29, s19, v146
v_xor_b32 v3, s26, v147
v_xor_b32 v144, s68, v144
v_xor_b32 v145, s69, v145
v_or_b32 v2, v144, v145
v_and_b32 v2, 0xff, v2
v_or3_b32 v29, v29, v3, v2
v_cmp_ne_u32 vcc, 0, v29
s_cbranch_vccnz L_ogr
v_mov_b32 v29, v144
s_nop 1
v_max_f32_dpp v29, v29, v29 row_ror:8 row_mask:0xf bank_mask:0xf
s_nop 1
v_max_f32_dpp v29, v29, v29 row_ror:4 row_mask:0xf bank_mask:0xf
s_nop 1
v_max_f32_dpp v29, v29, v29 row_ror:2 row_mask:0xf bank_mask:0xf
s_nop 1
v_max_f32_dpp v29, v29, v29 row_ror:1 row_mask:0xf bank_mask:0xf
v_sub_f32 v29, v144, v29
v_mul_f32 v29, s20, v29
v_exp_f32 v29, v29
s_nop 0
v_mul_f32 v3, v29, v145
s_nop 1
v_add_f32_dpp v3, v3, v3 row_ror:8 row_mask:0xf bank_mask:0xf
s_nop 1
v_add_f32_dpp v3, v3, v3 row_ror:4 row_mask:0xf bank_mask:0xf
s_nop 1
v_add_f32_dpp v3, v3, v3 row_ror:2 row_mask:0xf bank_mask:0xf
s_nop 1
v_add_f32_dpp v3, v3, v3 row_ror:1 row_mask:0xf bank_mask:0xf
v_rcp_f32 v3, v3
s_nop 0
v_mul_f32 v29, v29, v3
ds_write_b32 v13, v29
ds_read_b128 v[208:211], v14 offset:0
ds_read_b128 v[212:215], v14 offset:64
ds_read_b128 v[216:219], v14 offset:128
ds_read_b128 v[220:223], v14 offset:192
L_og:
s_waitcnt vmcnt(3)
v_xor_b32 v96, v240, v96
v_xor_b32 v97, v241, v97
v_xor_b32 v98, v242, v98
v_xor_b32 v99, v243, v99
v_lshl_or_b32 v160, v96, 16, s72
v_and_b32 v161, s25, v96
v_lshl_or_b32 v162, v97, 16, s72
v_and_b32 v163, s25, v97
v_lshl_or_b32 v164, v98, 16, s72
v_and_b32 v165, s25, v98
v_lshl_or_b32 v166, v99, 16, s72
v_and_b32 v167, s25, v99
v_or_b32 v29, v96, v97
v_or3_b32 v29, v98, v99, v29
s_waitcnt vmcnt(2)
v_xor_b32 v100, v240, v100
v_xor_b32 v101, v241, v101
v_xor_b32 v102, v242, v102
v_xor_b32 v103, v243, v103
v_lshl_or_b32 v168, v100, 16, s72
v_and_b32 v169, s25, v100
v_lshl_or_b32 v170, v101, 16, s72
v_and_b32 v171, s25, v101
v_lshl_or_b32 v172, v102, 16, s72
v_and_b32 v173, s25, v102
v_lshl_or_b32 v174, v103, 16, s72
v_and_b32 v175, s25, v103
v_or3_b32 v29, v100, v101, v29
v_or3_b32 v29, v102, v103, v29
s_waitcnt vmcnt(1)
v_xor_b32 v104, v240, v104
v_xor_b32 v105, v241, v105
v_xor_b32 v106, v242, v106
v_xor_b32 v107, v243, v107
v_lshl_or_b32 v176, v104, 16, s72
v_and_b32 v177, s25, v104
v_lshl_or_b32 v178, v105, 16, s72
v_and_b32 v179, s25, v105
v_lshl_or_b32 v180, v106, 16, s72
v_and_b32 v181, s25, v106
v_lshl_or_b32 v182, v107, 16, s72
v_and_b32 v183, s25, v107
v_or3_b32 v29, v104, v105, v29
v_or3_b32 v29, v106, v107, v29
s_waitcnt vmcnt(0)
v_xor_b32 v108, v240, v108
v_xor_b32 v109, v241, v109
v_xor_b32 v110, v242, v110
v_xor_b32 v111, v243, v111
v_lshl_or_b32 v184, v108, 16, s72
v_and_b32 v185, s25, v108
v_lshl_or_b32 v186, v109, 16, s72
v_and_b32 v187, s25, v109
v_lshl_or_b32 v188, v110, 16, s72
v_and_b32 v189, s25, v110
v_lshl_or_b32 v190, v111, 16, s72
v_and_b32 v191, s25, v111
v_or3_b32 v29, v108, v109, v29
v_or3_b32 v29, v110, v111, v29
v_and_b32 v29, 1, v29
v_cmp_ne_u32 vcc, 0, v29
s_cbranch_vccnz L_ogr
L_ogo:
s_waitcnt lgkmcnt(0)
v_pk_mul_f32 v[136:137], v[160:161], v[208:209]
v_pk_mul_f32 v[140:141], v[164:165], v[208:209]
v_pk_mul_f32 v[138:139], v[162:163], v[210:211]
v_pk_mul_f32 v[142:143], v[166:167], v[210:211]
v_pk_fma_f32 v[136:137], v[168:169], v[212:213], v[136:137]
v_pk_fma_f32 v[140:141], v[172:173], v[212:213], v[140:141]
v_pk_fma_f32 v[138:139], v[170:171], v[214:215], v[138:139]
v_pk_fma_f32 v[142:143], v[174:175], v[214:215], v[142:143]
v_pk_fma_f32 v[136:137], v[176:177], v[216:217], v[136:137]
v_pk_fma_f32 v[140:141], v[180:181], v[216:217], v[140:141]
v_pk_fma_f32 v[138:139], v[178:179], v[218:219], v[138:139]
v_pk_fma_f32 v[142:143], v[182:183], v[218:219], v[142:143]
v_pk_fma_f32 v[136:137], v[184:185], v[220:221], v[136:137]
v_pk_fma_f32 v[140:141], v[188:189], v[220:221], v[140:141]
v_pk_fma_f32 v[138:139], v[186:187], v[222:223], v[138:139]
v_pk_fma_f32 v[142:143], v[190:191], v[222:223], v[142:143]
s_nop 0
v_permlane32_swap_b32 v136, v140
v_permlane32_swap_b32 v137, v141
v_permlane32_swap_b32 v138, v142
v_permlane32_swap_b32 v139, v143
v_add_f32 v136, v136, v140
v_add_f32 v138, v138, v142
v_add_f32 v137, v137, v141
v_add_f32 v139, v139, v143
s_nop 0
v_permlane16_swap_b32 v136, v138
v_permlane16_swap_b32 v137, v139
s_nop 0
v_add_f32 v136, v136, v138
v_add_f32 v137, v137, v139
v_cvt_pk_bf16_f32 v136, v136, v137
ds_write_b32 v157, v136
s_waitcnt lgkmcnt(0)
s_barrier
s_cmp_lg_u32 s3, 0
s_cbranch_scc1 L_end
s_cmp_ge_u32 s2, 128
s_cbranch_scc1 L_end
s_mov_b32 s99, 262144
buffer_load_dwordx4 v[96:99], v4, s[56:59], s21 offen offset:0 sc1
buffer_load_dwordx4 v[100:103], v4, s[56:59], s21 offen offset:1024 sc1
buffer_load_dwordx4 v[104:107], v4, s[56:59], s21 offen offset:2048 sc1
buffer_load_dwordx4 v[108:111], v4, s[56:59], s21 offen offset:3072 sc1
L_fg:
buffer_load_dwordx4 v[112:115], v4, s[56:59], s21 offen offset:0 sc1
buffer_load_dwordx4 v[116:119], v4, s[56:59], s21 offen offset:1024 sc1
buffer_load_dwordx4 v[120:123], v4, s[56:59], s21 offen offset:2048 sc1
buffer_load_dwordx4 v[124:127], v4, s[56:59], s21 offen offset:3072 sc1
s_waitcnt vmcnt(7)
v_xor_b32 v96, v240, v96
v_xor_b32 v97, v241, v97
v_xor_b32 v98, v242, v98
v_xor_b32 v99, v243, v99
v_lshl_or_b32 v136, v96, 16, s72
v_and_b32 v137, s25, v96
v_lshl_or_b32 v138, v97, 16, s72
v_and_b32 v139, s25, v97
v_lshl_or_b32 v140, v98, 16, s72
v_and_b32 v141, s25, v98
v_lshl_or_b32 v142, v99, 16, s72
v_and_b32 v143, s25, v99
v_or_b32 v29, v96, v97
v_or3_b32 v29, v98, v99, v29
s_waitcnt vmcnt(6)
v_xor_b32 v100, v240, v100
v_xor_b32 v101, v241, v101
v_xor_b32 v102, v242, v102
v_xor_b32 v103, v243, v103
v_lshl_or_b32 v160, v100, 16, s72
v_and_b32 v161, s25, v100
v_lshl_or_b32 v162, v101, 16, s72
v_and_b32 v163, s25, v101
v_lshl_or_b32 v164, v102, 16, s72
v_and_b32 v165, s25, v102
v_lshl_or_b32 v166, v103, 16, s72
v_and_b32 v167, s25, v103
v_or3_b32 v29, v100, v101, v29
v_or3_b32 v29, v102, v103, v29
v_pk_add_f32 v[136:137], v[160:161], v[136:137]
v_pk_add_f32 v[140:141], v[164:165], v[140:141]
v_pk_add_f32 v[138:139], v[162:163], v[138:139]
v_pk_add_f32 v[142:143], v[166:167], v[142:143]
s_waitcnt vmcnt(5)
v_xor_b32 v104, v240, v104
v_xor_b32 v105, v241, v105
v_xor_b32 v106, v242, v106
v_xor_b32 v107, v243, v107
v_lshl_or_b32 v160, v104, 16, s72
v_and_b32 v161, s25, v104
v_lshl_or_b32 v162, v105, 16, s72
v_and_b32 v163, s25, v105
v_lshl_or_b32 v164, v106, 16, s72
v_and_b32 v165, s25, v106
v_lshl_or_b32 v166, v107, 16, s72
v_and_b32 v167, s25, v107
v_or3_b32 v29, v104, v105, v29
v_or3_b32 v29, v106, v107, v29
v_pk_add_f32 v[136:137], v[160:161], v[136:137]
v_pk_add_f32 v[140:141], v[164:165], v[140:141]
v_pk_add_f32 v[138:139], v[162:163], v[138:139]
v_pk_add_f32 v[142:143], v[166:167], v[142:143]
s_waitcnt vmcnt(4)
v_xor_b32 v108, v240, v108
v_xor_b32 v109, v241, v109
v_xor_b32 v110, v242, v110
v_xor_b32 v111, v243, v111
v_lshl_or_b32 v160, v108, 16, s72
v_and_b32 v161, s25, v108
v_lshl_or_b32 v162, v109, 16, s72
v_and_b32 v163, s25, v109
v_lshl_or_b32 v164, v110, 16, s72
v_and_b32 v165, s25, v110
v_lshl_or_b32 v166, v111, 16, s72
v_and_b32 v167, s25, v111
v_or3_b32 v29, v108, v109, v29
v_or3_b32 v29, v110, v111, v29
v_pk_add_f32 v[136:137], v[160:161], v[136:137]
v_pk_add_f32 v[140:141], v[164:165], v[140:141]
v_pk_add_f32 v[138:139], v[162:163], v[138:139]
v_pk_add_f32 v[142:143], v[166:167], v[142:143]
v_and_b32 v29, 1, v29
v_cmp_ne_u32 vcc, 0, v29
s_cbranch_vccz L_fgo
buffer_load_dwordx4 v[96:99], v4, s[56:59], s21 offen offset:0 sc1
buffer_load_dwordx4 v[100:103], v4, s[56:59], s21 offen offset:1024 sc1
buffer_load_dwordx4 v[104:107], v4, s[56:59], s21 offen offset:2048 sc1
buffer_load_dwordx4 v[108:111], v4, s[56:59], s21 offen offset:3072 sc1
s_sub_u32 s99, s99, 1
s_cbranch_scc1 L_fgo
s_waitcnt vmcnt(7)
v_xor_b32 v112, v240, v112
v_xor_b32 v113, v241, v113
v_xor_b32 v114, v242, v114
v_xor_b32 v115, v243, v115
v_lshl_or_b32 v136, v112, 16, s72
v_and_b32 v137, s25, v112
v_lshl_or_b32 v138, v113, 16, s72
v_and_b32 v139, s25, v113
v_lshl_or_b32 v140, v114, 16, s72
v_and_b32 v141, s25, v114
v_lshl_or_b32 v142, v115, 16, s72
v_and_b32 v143, s25, v115
v_or_b32 v29, v112, v113
v_or3_b32 v29, v114, v115, v29
s_waitcnt vmcnt(6)
v_xor_b32 v116, v240, v116
v_xor_b32 v117, v241, v117
v_xor_b32 v118, v242, v118
v_xor_b32 v119, v243, v119
v_lshl_or_b32 v160, v116, 16, s72
v_and_b32 v161, s25, v116
v_lshl_or_b32 v162, v117, 16, s72
v_and_b32 v163, s25, v117
v_lshl_or_b32 v164, v118, 16, s72
v_and_b32 v165, s25, v118
v_lshl_or_b32 v166, v119, 16, s72
v_and_b32 v167, s25, v119
v_or3_b32 v29, v116, v117, v29
v_or3_b32 v29, v118, v119, v29
v_pk_add_f32 v[136:137], v[160:161], v[136:137]
v_pk_add_f32 v[140:141], v[164:165], v[140:141]
v_pk_add_f32 v[138:139], v[162:163], v[138:139]
v_pk_add_f32 v[142:143], v[166:167], v[142:143]
s_waitcnt vmcnt(5)
v_xor_b32 v120, v240, v120
v_xor_b32 v121, v241, v121
v_xor_b32 v122, v242, v122
v_xor_b32 v123, v243, v123
v_lshl_or_b32 v160, v120, 16, s72
v_and_b32 v161, s25, v120
v_lshl_or_b32 v162, v121, 16, s72
v_and_b32 v163, s25, v121
v_lshl_or_b32 v164, v122, 16, s72
v_and_b32 v165, s25, v122
v_lshl_or_b32 v166, v123, 16, s72
v_and_b32 v167, s25, v123
v_or3_b32 v29, v120, v121, v29
v_or3_b32 v29, v122, v123, v29
v_pk_add_f32 v[136:137], v[160:161], v[136:137]
v_pk_add_f32 v[140:141], v[164:165], v[140:141]
v_pk_add_f32 v[138:139], v[162:163], v[138:139]
v_pk_add_f32 v[142:143], v[166:167], v[142:143]
s_waitcnt vmcnt(4)
v_xor_b32 v124, v240, v124
v_xor_b32 v125, v241, v125
v_xor_b32 v126, v242, v126
v_xor_b32 v127, v243, v127
v_lshl_or_b32 v160, v124, 16, s72
v_and_b32 v161, s25, v124
v_lshl_or_b32 v162, v125, 16, s72
v_and_b32 v163, s25, v125
v_lshl_or_b32 v164, v126, 16, s72
v_and_b32 v165, s25, v126
v_lshl_or_b32 v166, v127, 16, s72
v_and_b32 v167, s25, v127
v_or3_b32 v29, v124, v125, v29
v_or3_b32 v29, v126, v127, v29
v_pk_add_f32 v[136:137], v[160:161], v[136:137]
v_pk_add_f32 v[140:141], v[164:165], v[140:141]
v_pk_add_f32 v[138:139], v[162:163], v[138:139]
v_pk_add_f32 v[142:143], v[166:167], v[142:143]
v_and_b32 v29, 1, v29
v_cmp_ne_u32 vcc, 0, v29
s_cbranch_vccnz L_fg
L_fgo:
v_permlane32_swap_b32 v136, v140
v_permlane32_swap_b32 v137, v141
v_permlane32_swap_b32 v138, v142
v_permlane32_swap_b32 v139, v143
v_add_f32 v136, v136, v140
v_add_f32 v138, v138, v142
v_add_f32 v137, v137, v141
v_add_f32 v139, v139, v143
s_nop 0
v_permlane16_swap_b32 v136, v138
v_permlane16_swap_b32 v137, v139
s_nop 0
v_add_f32 v136, v136, v138
v_add_f32 v137, v137, v139
s_nop 0
v_add_f32_dpp v136, v136, v136 row_ror:8 row_mask:0xf bank_mask:0xf
v_add_f32_dpp v137, v137, v137 row_ror:8 row_mask:0xf bank_mask:0xf
v_cndmask_b32 v136, v136, v137, s[16:17]
s_nop 1
v_mov_b32_dpp v137, v136 row_shl:1 row_mask:0xf bank_mask:0xf
v_cvt_pk_bf16_f32 v136, v136, v137
s_nop 1
v_mov_b32_dpp v137, v136 row_shl:2 row_mask:0xf bank_mask:0xf
v_mov_b32_dpp v138, v136 row_shl:4 row_mask:0xf bank_mask:0xf
v_mov_b32_dpp v139, v136 row_shl:6 row_mask:0xf bank_mask:0xf
s_mov_b32 exec_lo, 0x01010101
s_mov_b32 exec_hi, 0x01010101
buffer_store_dwordx4 v[136:139], v15, s[64:67], s22 offen sc1
s_cmp_eq_u32 s2, 0
s_cselect_b32 s13, 393216, s58
v_mov_b32 v2, s19
v_mov_b32 v3, s27
s_mov_b64 exec, 1
buffer_store_dwordx2 v[2:3], v15, s[56:59], s13 offen sc1
L_end:
s_endpgm
L_ogr:
s_sub_u32 s76, s76, 1
s_cbranch_scc1 L_ogo
s_waitcnt vmcnt(0)
buffer_load_dwordx4 v[144:147], v156, s[56:59], s24 offen sc1
buffer_load_dwordx4 v[136:139], v159, s[56:59], s23 offen sc1
s_waitcnt vmcnt(0)
L_chk74:
v_xor_b32 v29, s19, v146
v_xor_b32 v3, s26, v147
v_xor_b32 v144, s68, v144
v_xor_b32 v145, s69, v145
v_or_b32 v2, v144, v145
v_and_b32 v2, 0xff, v2
v_or3_b32 v29, v29, v3, v2
v_cmp_ne_u32 vcc, 0, v29
v_xor_b32 v136, v244, v136
v_xor_b32 v137, v245, v137
v_xor_b32 v138, v246, v138
v_xor_b32 v139, v247, v139
v_or3_b32 v3, v136, v137, v138
v_or_b32 v3, v3, v139
v_and_or_b32 v29, v3, 1, v29
v_cmp_ne_u32 vcc, 0, v29
s_cbranch_vccz L_ok74
s_cmp_eq_u32 s76, 0
s_cbranch_scc1 L_ok74
s_sub_u32 s76, s76, 1
s_sleep 8
buffer_load_dwordx4 v[144:147], v156, s[56:59], s24 offen sc1
buffer_load_dwordx4 v[136:139], v159, s[56:59], s23 offen sc1
s_waitcnt vmcnt(0)
s_branch L_chk74
L_ok74:
buffer_load_dwordx4 v[96:99], v4, s[56:59], s23 offen offset:0 sc1
buffer_load_dwordx4 v[100:103], v4, s[56:59], s23 offen offset:1024 sc1
buffer_load_dwordx4 v[104:107], v4, s[56:59], s23 offen offset:2048 sc1
buffer_load_dwordx4 v[108:111], v4, s[56:59], s23 offen offset:3072 sc1
v_mov_b32 v29, v144
s_nop 1
v_max_f32_dpp v29, v29, v29 row_ror:8 row_mask:0xf bank_mask:0xf
s_nop 1
v_max_f32_dpp v29, v29, v29 row_ror:4 row_mask:0xf bank_mask:0xf
s_nop 1
v_max_f32_dpp v29, v29, v29 row_ror:2 row_mask:0xf bank_mask:0xf
s_nop 1
v_max_f32_dpp v29, v29, v29 row_ror:1 row_mask:0xf bank_mask:0xf
v_sub_f32 v29, v144, v29
v_mul_f32 v29, s20, v29
v_exp_f32 v29, v29
s_nop 0
v_mul_f32 v3, v29, v145
s_nop 1
v_add_f32_dpp v3, v3, v3 row_ror:8 row_mask:0xf bank_mask:0xf
s_nop 1
v_add_f32_dpp v3, v3, v3 row_ror:4 row_mask:0xf bank_mask:0xf
s_nop 1
v_add_f32_dpp v3, v3, v3 row_ror:2 row_mask:0xf bank_mask:0xf
s_nop 1
v_add_f32_dpp v3, v3, v3 row_ror:1 row_mask:0xf bank_mask:0xf
v_rcp_f32 v3, v3
s_nop 0
v_mul_f32 v29, v29, v3
ds_write_b32 v13, v29
ds_read_b128 v[208:211], v14 offset:0
ds_read_b128 v[212:215], v14 offset:64
ds_read_b128 v[216:219], v14 offset:128
ds_read_b128 v[220:223], v14 offset:192
s_branch L_og
.section .rodata,"a"
.p2align 6
.amdhsa_kernel concat_heads__sliding_block_cached__gqa_block_cached__decode_kernel
  .amdhsa_next_free_vgpr 256
  .amdhsa_next_free_sgpr 102
  .amdhsa_accum_offset 256
  .amdhsa_group_segment_fixed_size 0
  .amdhsa_kernarg_size 104
  .amdhsa_user_sgpr_count 2
  .amdhsa_user_sgpr_kernarg_segment_ptr 1
  .amdhsa_system_sgpr_workgroup_id_x 1
.end_amdhsa_kernel
```
